```python
import torch

def _softmax(x, axis=-1):
    return torch.softmax(x, dim=axis)
def _gelu(x):
    return torch.nn.functional.gelu(x, approximate="tanh")
def _silu(x):
    return torch.nn.functional.silu(x)
def _sigmoid(x):
    return torch.sigmoid(x)
def _layernorm(x, axis=-1, eps=1e-5):
    m = x.mean(dim=axis, keepdim=True)
    v = x.var(dim=axis, keepdim=True, unbiased=False)
    return (x - m) / torch.sqrt(v + eps)
def _scatter_add(tgt, idx, src, axis=0):
    return tgt.clone().index_add_(axis, idx, src)
def _segment_sum(src, seg, n):
    out = torch.zeros((n,) + src.shape[1:], dtype=src.dtype)
    return out.index_add_(0, seg, src)
def _pad(x, pw):
    flat = tuple(v for pair in reversed(pw) for v in pair)
    return torch.nn.functional.pad(x, flat)

kernel_name = 'parallel_sum__ssm_conv_s5__glu_gated_bilinear__prompt'

def setup_inputs():

    _w = (lambda a: (lambda t: t.to(torch.bfloat16) if t.is_floating_point() else t)(torch.as_tensor(a)))
    def _A_setup():
        B, S, D = 1, 2048, 512
        P = D
        Lambda_re = -0.5 * (lambda _x: torch.exp(torch.as_tensor(_x)))((lambda *s: torch.randn(*s, dtype=torch.bfloat16) * 0.2)(P))
        Lambda_im = (lambda *s: torch.randn(*s, dtype=torch.bfloat16) * 0.8)(P) * 1.0
        B_re = (lambda *s: torch.randn(*s, dtype=torch.bfloat16) * 0.2)(P, D) * (D ** -0.5)
        B_im = (lambda *s: torch.randn(*s, dtype=torch.bfloat16) * 0.2)(P, D) * (D ** -0.5)
        C_re = (lambda *s: torch.randn(*s, dtype=torch.bfloat16) * 0.2)(D, P) * (P ** -0.5)
        C_im = (lambda *s: torch.randn(*s, dtype=torch.bfloat16) * 0.2)(D, P) * (P ** -0.5)
        log_dt = (lambda *s: torch.randn(*s, dtype=torch.bfloat16) * 0.2)(P) * 0.3 - 2.0
        Dskip = (lambda *s: torch.randn(*s, dtype=torch.bfloat16) * 0.05)(D)
        return {
            "x": _w((lambda *s: torch.randn(*s, dtype=torch.bfloat16) * 0.05)(B, S, D)),
            "Lambda_re": _w(Lambda_re),
            "Lambda_im": _w(Lambda_im),
            "B_re": _w(B_re),
            "B_im": _w(B_im),
            "C_re": _w(C_re),
            "C_im": _w(C_im),
            "log_dt": _w(log_dt),
            "Dskip": _w(Dskip),
        }
    _A_in = _A_setup()

    def _B_setup():
        B, S, D, F = 1, 2048, 512, 1376
        return {
            "x": _w((lambda *s: torch.randn(*s, dtype=torch.bfloat16) * 0.05)(B, S, D)),
            "w_gate": _w((lambda *s: torch.randn(*s, dtype=torch.bfloat16) * 0.4)(D, F) * (D ** -0.5)),
            "w_up": _w((lambda *s: torch.randn(*s, dtype=torch.bfloat16) * 0.4)(D, F) * (D ** -0.5)),
            "w_down": _w((lambda *s: torch.randn(*s, dtype=torch.bfloat16) * 0.4)(F, D) * (F ** -0.5)),
        }
    _B_in = _B_setup()

    return {
        "A_x": _A_in["x"],
        "A_Lambda_re": _A_in["Lambda_re"],
        "A_Lambda_im": _A_in["Lambda_im"],
        "A_B_re": _A_in["B_re"],
        "A_B_im": _A_in["B_im"],
        "A_C_re": _A_in["C_re"],
        "A_C_im": _A_in["C_im"],
        "A_log_dt": _A_in["log_dt"],
        "A_Dskip": _A_in["Dskip"],
        "B_x": _B_in["x"],
        "B_w_gate": _B_in["w_gate"],
        "B_w_up": _B_in["w_up"],
        "B_w_down": _B_in["w_down"],
    }

def reference(A_x, A_Lambda_re, A_Lambda_im, A_B_re, A_B_im, A_C_re, A_C_im, A_log_dt, A_Dskip, B_x, B_w_gate, B_w_up, B_w_down):
    def _A_ref(x, Lambda_re, Lambda_im, B_re, B_im, C_re, C_im, log_dt, Dskip):
        Bsz, L, H = x.shape
        Lam = Lambda_re + 1j * Lambda_im
        Bmat = B_re + 1j * B_im
        Cmat = C_re + 1j * C_im
        dt = torch.exp(log_dt)
        Lam_bar = torch.exp(dt * Lam)
        B_bar = ((Lam_bar - 1.0) / Lam)[:, None] * Bmat
        Bu = torch.einsum("bld,pd->blp", x + 0j, B_bar)
        h = torch.zeros_like(Bu[:, 0, :])
        hs = []
        for t in range(L):
            h = Lam_bar[None, :] * h + Bu[:, t, :]
            hs.append(h)
        hseq = torch.stack(hs, 1)
        y = 2.0 * torch.einsum("blp,dp->bld", hseq, Cmat).real + x * Dskip[None, None, :]
        return y

    def _B_ref(x, w_gate, w_up, w_down):
        g = torch.einsum("bsd,df->bsf", x, w_gate)
        u = torch.einsum("bsd,df->bsf", x, w_up)
        h = g * u
        return torch.einsum("bsf,fd->bsd", h, w_down)

    x = A_x
    xn = _layernorm(x, axis=-1)
    return x + _A_ref(xn, A_Lambda_re, A_Lambda_im, A_B_re, A_B_im, A_C_re, A_C_im, A_log_dt, A_Dskip) + _B_ref(xn, B_w_gate, B_w_up, B_w_down)
```

```asm
; @launch grid=(256,1,1) block=(512,1,1) lds=163840
.amdgcn_target "amdgcn-amd-amdhsa--gfx950"
.text
.globl parallel_sum__ssm_conv_s5__glu_gated_bilinear__prompt_kernel
.p2align 8
.type parallel_sum__ssm_conv_s5__glu_gated_bilinear__prompt_kernel,@function
parallel_sum__ssm_conv_s5__glu_gated_bilinear__prompt_kernel:
  s_cmp_ge_u32 s2, 256
  s_cbranch_scc1 L_end
  s_load_dwordx16 s[16:31], s[0:1], 0
  s_getpc_b64 s[98:99]
  s_bfe_u32 s9, s2, 0x20003
  v_lshrrev_b32 v80, 3, v0
  v_lshl_add_u32 v80, v80, 2, s9
  v_lshlrev_b32 v80, 7, v80
  global_load_dword v95, v80, s[98:99]
  s_load_dwordx16 s[32:47], s[0:1], 64
  s_memrealtime s[14:15]
  v_lshrrev_b32 v80, 6, v0
  v_and_b32 v1, 63, v0
  v_readfirstlane_b32 s12, v80
  s_bfe_u32 s9, s2, 0x20001
  s_lshr_b32 s101, s2, 6
  s_lshl2_add_u32 s4, s9, s101
  s_bfe_u32 s6, s2, 0x30003
  s_lshl1_add_u32 s8, s101, s6
  s_and_b32 s7, s2, 1
  s_lshl3_add_u32 s5, s7, s6
  s_mov_b32 s95, s6
  s_add_u32 s8, s8, s9
  s_add_u32 s80, s8, 0
  s_and_b32 s80, s80, 7
  s_lshl_b32 s80, s80, 7
  s_add_u32 s81, s8, 1
  s_and_b32 s81, s81, 7
  s_lshl_b32 s81, s81, 7
  s_and_b32 s3, s12, 3
  s_lshl_b32 s88, s3, 12
  v_lshrrev_b32 v81, 3, v1
  v_and_b32 v82, 7, v1
  v_lshrrev_b32 v84, 1, v81
  v_xor_b32 v83, v82, v84
  v_lshlrev_b32 v83, 4, v83
  v_xor_b32 v85, 64, v83
  v_lshlrev_b32 v78, 2, v1
  v_mov_b32 v79, 0
  v_add_u32 v78, 163328, v78
  ds_write_b32 v78, v79
  s_mov_b32 s99, 0x1000000
  s_and_b32 s98, s101, 3
  s_cmp_ge_u32 s12, 4
  s_cbranch_scc1 L_helper
  v_and_b32 v84, 4, v81
  v_and_b32 v80, 3, v81
  v_lshl_add_u32 v84, v84, 2, v80
  s_lshl2_add_u32 s9, s4, s3
  s_lshl_b32 s9, s9, 5
  v_add_lshl_u32 v84, v84, s9, 10
  v_add_u32 v86, v84, v83
  v_add_u32 v87, v84, v85
  v_add_u32 v88, 6144, v86
  v_add_u32 v89, 9216, v87
  v_add_u32 v87, 3072, v87
  s_mov_b32 s50, 2097152
  s_mov_b32 s51, 0x20000
  s_waitcnt lgkmcnt(0)
  s_mov_b64 s[48:49], s[16:17]
  s_add_u32 m0, s88, 0
  s_nop 0
  buffer_load_dwordx4 v86, s[48:51], s80 offen lds
  buffer_load_dwordx4 v87, s[48:51], s80 offen offset:1024 lds
  buffer_load_dwordx4 v88, s[48:51], s80 offen offset:2048 lds
  buffer_load_dwordx4 v89, s[48:51], s80 offen offset:3072 lds
  s_add_u32 m0, s88, 16384
  s_nop 0
  buffer_load_dwordx4 v86, s[48:51], s81 offen lds
  buffer_load_dwordx4 v87, s[48:51], s81 offen offset:1024 lds
  buffer_load_dwordx4 v88, s[48:51], s81 offen offset:2048 lds
  buffer_load_dwordx4 v89, s[48:51], s81 offen offset:3072 lds
  s_setprio 1
  s_add_u32 s82, s8, 2
  s_and_b32 s82, s82, 7
  s_lshl_b32 s82, s82, 7
  s_add_u32 s83, s8, 3
  s_and_b32 s83, s83, 7
  s_lshl_b32 s83, s83, 7
  s_add_u32 s84, s8, 4
  s_and_b32 s84, s84, 7
  s_lshl_b32 s84, s84, 7
  s_add_u32 s85, s8, 5
  s_and_b32 s85, s85, 7
  s_lshl_b32 s85, s85, 7
  s_add_u32 s86, s8, 6
  s_and_b32 s86, s86, 7
  s_lshl_b32 s86, s86, 7
  s_add_u32 s87, s8, 7
  s_and_b32 s87, s87, 7
  s_lshl_b32 s87, s87, 7
  s_add_u32 m0, s88, 32768
  s_nop 0
  buffer_load_dwordx4 v86, s[48:51], s82 offen lds
  buffer_load_dwordx4 v87, s[48:51], s82 offen offset:1024 lds
  buffer_load_dwordx4 v88, s[48:51], s82 offen offset:2048 lds
  buffer_load_dwordx4 v89, s[48:51], s82 offen offset:3072 lds
  s_barrier
  s_branch L_cmain
L_helper:
  s_and_b32 s10, s3, 1
  s_lshl1_add_u32 s9, s5, s10
  s_lshl_b32 s9, s9, 4
  v_add_lshl_u32 v84, v81, s9, 10
  v_add_u32 v2, v84, v83
  v_add_u32 v3, v84, v85
  v_add_u32 v3, 7168, v3
  s_lshl_b32 s89, s3, 11
  s_waitcnt lgkmcnt(0)
  s_cmp_ge_u32 s3, 2
  s_cselect_b64 s[52:53], s[24:25], s[22:23]
  s_mov_b32 s54, 524288
  s_mov_b32 s55, 0x20000
  s_cselect_b64 s[56:57], s[38:39], s[36:37]
  s_mov_b32 s58, 1409024
  s_mov_b32 s59, 0x20000
  s_cselect_b64 s[60:61], s[28:29], s[26:27]
  s_mov_b32 s62, 524288
  s_mov_b32 s63, 0x20000
  s_add_u32 m0, s89, 65536
  s_nop 0
  buffer_load_dwordx4 v2, s[52:55], s80 offen lds
  buffer_load_dwordx4 v3, s[52:55], s80 offen offset:1024 lds
  s_add_u32 m0, s89, 73728
  s_nop 0
  buffer_load_dwordx4 v2, s[52:55], s81 offen lds
  buffer_load_dwordx4 v3, s[52:55], s81 offen offset:1024 lds
  s_barrier
  s_lshl2_add_u32 s9, s5, s3
  s_lshl_b32 s9, s9, 3
  v_add_lshl_u32 v87, v82, s9, 1
  global_load_ushort v70, v87, s[30:31]
  global_load_ushort v71, v87, s[18:19]
  global_load_ushort v72, v87, s[20:21]
  s_lshl1_add_u32 s9, s6, s10
  s_lshl_b32 s9, s9, 5
  v_and_b32 v87, 31, v1
  v_add_lshl_u32 v87, v87, s9, 1
  global_load_ushort v7, v87, s[32:33]
  s_mov_b64 s[76:77], s[44:45]
  s_mov_b32 s78, 256
  s_mov_b32 s79, 0x20000
  s_or_b32 s9, s2, s3
  s_cbranch_scc1 L_notag
  s_or_b32 s13, s14, 1
  s_mul_i32 s13, s13, 0x9E3779B1
  v_mov_b32 v93, s13
  v_mov_b32 v94, 0
  s_mov_b64 exec, 1
  buffer_store_dword v93, v94, s[76:79], 0 offen sc1
  s_mov_b64 exec, -1
L_notag:
  s_add_u32 s82, s8, 2
  s_and_b32 s82, s82, 7
  s_lshl_b32 s82, s82, 7
  s_add_u32 s83, s8, 3
  s_and_b32 s83, s83, 7
  s_lshl_b32 s83, s83, 7
  s_add_u32 s84, s8, 4
  s_and_b32 s84, s84, 7
  s_lshl_b32 s84, s84, 7
  s_add_u32 s85, s8, 5
  s_and_b32 s85, s85, 7
  s_lshl_b32 s85, s85, 7
  s_add_u32 s86, s8, 6
  s_and_b32 s86, s86, 7
  s_lshl_b32 s86, s86, 7
  s_add_u32 s87, s8, 7
  s_and_b32 s87, s87, 7
  s_lshl_b32 s87, s87, 7
  s_mov_b64 s[48:49], s[16:17]
  s_mov_b32 s50, 2097152
  s_mov_b32 s51, 0x20000
  s_mov_b64 s[64:65], s[40:41]
  s_mov_b32 s66, 1409024
  s_mov_b32 s67, 0x20000
  s_mov_b64 s[68:69], s[46:47]
  s_mov_b32 s70, 25165824
  s_mov_b32 s71, 0x20000
  s_lshl4_add_u32 s9, s4, s5
  s_lshl_b32 s9, s9, 7
  s_add_u32 s9, s9, 10747904
  s_add_u32 s72, s46, s9
  s_addc_u32 s73, s47, 0
  v_and_b32 v160, 3, v1
  v_lshlrev_b32 v160, 2, v160
  v_add_u32 v160, 163328, v160
  v_mov_b32 v162, 0
  s_lshl_b32 s9, s3, 2
  s_add_u32 s9, s9, 163328
  v_mov_b32 v163, s9
  s_add_u32 m0, s89, 81920
  s_nop 0
  buffer_load_dwordx4 v2, s[52:55], s82 offen lds
  buffer_load_dwordx4 v3, s[52:55], s82 offen offset:1024 lds
  s_add_u32 m0, s89, 90112
  s_nop 0
  buffer_load_dwordx4 v2, s[52:55], s83 offen lds
  buffer_load_dwordx4 v3, s[52:55], s83 offen offset:1024 lds
  s_add_u32 m0, s89, 98304
  s_nop 0
  buffer_load_dwordx4 v2, s[52:55], s84 offen lds
  buffer_load_dwordx4 v3, s[52:55], s84 offen offset:1024 lds
  s_add_u32 m0, s89, 106496
  s_nop 0
  buffer_load_dwordx4 v2, s[52:55], s85 offen lds
  buffer_load_dwordx4 v3, s[52:55], s85 offen offset:1024 lds
  s_add_u32 m0, s89, 114688
  s_nop 0
  buffer_load_dwordx4 v2, s[52:55], s86 offen lds
  buffer_load_dwordx4 v3, s[52:55], s86 offen offset:1024 lds
  s_add_u32 m0, s89, 122880
  s_nop 0
  buffer_load_dwordx4 v2, s[52:55], s87 offen lds
  buffer_load_dwordx4 v3, s[52:55], s87 offen offset:1024 lds
  s_waitcnt vmcnt(8)
  v_mov_b32 v162, 2
  ds_write_b32 v163, v162 offset:16
  s_mov_b32 s97, 0
  s_mov_b32 s15, 0
  s_mul_i32 s94, s3, 6144
  s_mul_i32 s9, s10, 88064
  s_mul_i32 s11, s5, 192
  s_add_u32 s9, s9, s11
  s_lshl_b32 s11, s7, 7
  s_sub_u32 s9, s9, s11
  s_mul_i32 s11, s6, 3
  s_mov_b32 s12, 2752
  v_mov_b32 v90, 2147483648
  s_add_u32 s11, s11, s7
  v_add_u32 v88, 0, v1
  v_mul_u32_u24 v86, 43691, v88
  v_lshrrev_b32 v86, 19, v86
  v_mul_u32_u24 v87, 12, v86
  v_sub_u32 v87, v88, v87
  v_mul_lo_u32 v86, v86, s12
  v_lshl_add_u32 v86, v87, 4, v86
  v_add_u32 v86, s9, v86
  v_lshrrev_b32 v87, 2, v87
  v_add_u32 v87, s11, v87
  v_cmp_gt_u32 vcc, 22, v87
  s_nop 1
  v_cndmask_b32 v4, v90, v86, vcc
  v_add_u32 v88, 64, v1
  v_mul_u32_u24 v86, 43691, v88
  v_lshrrev_b32 v86, 19, v86
  v_mul_u32_u24 v87, 12, v86
  v_sub_u32 v87, v88, v87
  v_mul_lo_u32 v86, v86, s12
  v_lshl_add_u32 v86, v87, 4, v86
  v_add_u32 v86, s9, v86
  v_lshrrev_b32 v87, 2, v87
  v_add_u32 v87, s11, v87
  v_cmp_gt_u32 vcc, 22, v87
  v_subrev_u32 v86, 1024, v86
  s_nop 0
  v_cndmask_b32 v5, v90, v86, vcc
  v_add_u32 v88, 128, v1
  v_mul_u32_u24 v86, 43691, v88
  v_lshrrev_b32 v86, 19, v86
  v_mul_u32_u24 v87, 12, v86
  v_sub_u32 v87, v88, v87
  v_mul_lo_u32 v86, v86, s12
  v_lshl_add_u32 v86, v87, 4, v86
  v_add_u32 v86, s9, v86
  v_lshrrev_b32 v87, 2, v87
  v_add_u32 v87, s11, v87
  v_cmp_gt_u32 vcc, 22, v87
  v_subrev_u32 v86, 2048, v86
  s_nop 0
  v_cndmask_b32 v6, v90, v86, vcc
  s_lshl2_add_u32 s9, s6, s10
  s_lshl_b32 s11, s5, 1
  s_sub_u32 s9, s9, s11
  s_lshl_b32 s9, s9, 14
  v_add_u32 v8, s9, v2
  v_add_u32 v9, s9, v3
  v_add_u32 v10, 14336, v8
  v_add_u32 v11, 14336, v9
  s_lshl_b32 s9, s3, 11
  s_add_u32 s9, s9, 152576
  v_lshl_add_u32 v86, v1, 4, s9
  ds_write_b128 v86, v[4:7]
  v_mov_b32 v92, v86
  s_waitcnt lgkmcnt(0)
  s_lshl_b32 s9, s3, 10
  s_add_u32 s9, s9, 148480
  v_lshl_add_u32 v40, v1, 3, s9
  v_mov_b32 v88, 0
  v_mov_b32 v89, 0
  ds_write_b64 v40, v[88:89]
  v_lshl_add_u32 v46, v82, 3, s9
  s_lshl_b32 s9, s3, 9
  v_lshlrev_b32 v86, 11, v81
  v_lshl_add_u32 v86, v82, 6, v86
  v_lshrrev_b32 v87, 1, v82
  v_lshl_add_u32 v86, v87, 4, v86
  v_add_u32 v50, s9, v86
  v_xor_b32 v51, 16, v50
  v_xor_b32 v52, 32, v50
  v_xor_b32 v53, 48, v50
  v_add_u32 v164, 98304, v50
  v_add_u32 v165, 98304, v51
  v_add_u32 v166, 98304, v52
  v_add_u32 v167, 98304, v53
L_spin16:
  ds_read_b32 v161, v160 offset:0
  s_sub_u32 s99, s99, 1
  s_cbranch_scc1 L_end
  s_waitcnt lgkmcnt(0)
  v_cmp_gt_u32 vcc, 2, v161
  s_cbranch_vccnz L_spin16
  v_mov_b32 v91, 0
  buffer_load_dword v21, v91, s[76:79], 0 offen sc1
  s_add_u32 m0, s94, 0
  s_mul_i32 s16, s80, 1376
  buffer_load_dwordx4 v4, s[56:59], s16 offen lds
  buffer_load_dwordx4 v5, s[56:59], s16 offen offset:1024 lds
  buffer_load_dwordx4 v6, s[56:59], s16 offen offset:2048 lds
  s_add_u32 m0, s94, 3072
  s_add_u32 s16, s16, 44032
  buffer_load_dwordx4 v4, s[56:59], s16 offen lds
  buffer_load_dwordx4 v5, s[56:59], s16 offen offset:1024 lds
  buffer_load_dwordx4 v6, s[56:59], s16 offen offset:2048 lds
  s_waitcnt vmcnt(7)
  v_mov_b32 v162, 4
  ds_write_b32 v163, v162 offset:16
  v_lshlrev_b32 v54, 6, v81
  v_add_u32 v54, 147456, v54
  s_lshl_b32 s9, s5, 13
  s_lshl_b32 s11, s3, 7
  s_add_u32 s9, s9, s11
  s_add_u32 s9, s9, 10485760
  v_lshl_add_u32 v86, v82, 4, s9
  s_lshl_b32 s11, s4, 9
  v_add_u32 v41, s11, v86
  v_cmp_eq_u32 vcc, 7, v81
  s_nop 1
  v_cndmask_b32 v41, v90, v41, vcc
  s_sub_u32 s11, s4, 16
  v_lshl_add_u32 v87, v81, 1, s11
  v_lshl_add_u32 v42, v87, 9, v86
  v_add_u32 v43, 512, v42
  v_cmp_le_i32 vcc, 0, v87
  s_nop 1
  v_cndmask_b32 v42, v90, v42, vcc
  v_cndmask_b32 v44, 0, -1, vcc
  v_cmp_le_i32 vcc, -1, v87
  s_nop 1
  v_cndmask_b32 v43, v90, v43, vcc
  v_cndmask_b32 v45, 0, -1, vcc
  s_mul_i32 s9, s3, 2608
  s_add_u32 s9, s9, 152576
  v_mul_u32_u24 v86, 336, v82
  v_lshl_add_u32 v86, v81, 5, v86
  v_add_u32 v47, s9, v86
  v_bfe_u32 v86, v1, 2, 2
  v_mul_u32_u24 v86, 336, v86
  v_and_b32 v87, 32, v1
  v_lshl_add_u32 v86, v87, 1, v86
  v_and_b32 v87, 1, v1
  v_lshl_add_u32 v86, v87, 5, v86
  v_and_b32 v87, 16, v1
  v_add_u32 v86, v86, v87
  v_and_b32 v87, 2, v1
  v_lshl_add_u32 v86, v87, 2, v86
  v_add_u32 v48, s9, v86
  s_mul_i32 s9, s4, 640
  s_lshr_b32 s11, s5, 1
  s_lshl3_add_u32 s9, s11, s9
  s_and_b32 s11, s5, 1
  s_lshl1_add_u32 s9, s11, s9
  s_lshl_b32 s9, s9, 10
  s_lshl_b32 s11, s3, 9
  s_add_u32 s9, s9, s11
  v_lshrrev_b32 v86, 5, v1
  v_mul_u32_u24 v86, 163840, v86
  v_and_b32 v87, 31, v1
  v_lshl_add_u32 v86, v87, 4, v86
  v_add_u32 v49, s9, v86
  v_lshlrev_b32 v70, 16, v70
  v_lshlrev_b32 v71, 16, v71
  v_lshlrev_b32 v72, 16, v72
  v_mul_f32 v70, 0x3fb8aa3b, v70
  v_exp_f32 v70, v70
  v_mul_f32 v74, v71, v71
  v_cvt_pk_bf16_f32 v70, v70, v70
  v_and_b32 v70, 0xffff0000, v70
  v_mul_f32 v75, v70, v71
  v_mul_f32 v76, v70, v72
  v_mul_f32 v75, 0x3fb8aa3b, v75
  v_exp_f32 v75, v75
  v_mul_f32 v76, 0.15915494, v76
  v_rndne_f32 v77, v76
  v_sub_f32 v76, v76, v77
  v_cos_f32 v77, v76
  v_sin_f32 v78, v76
  v_fmac_f32 v74, v72, v72
  v_mul_f32 v22, v75, v77
  v_mul_f32 v78, v75, v78
  v_rcp_f32 v74, v74
  v_add_f32 v77, -1.0, v22
  v_add_f32 v74, v74, v74
  v_mul_f32 v24, v77, v71
  v_fmac_f32 v24, v78, v72
  v_mul_f32 v24, v24, v74
  v_mul_f32 v25, v77, v72
  v_fma_f32 v25, -v78, v71, v25
  v_mul_f32 v25, v25, v74
  v_sub_f32 v23, 0, v78
  v_mul_f32 v78, v23, v23
  v_add_f32 v79, v22, v22
  v_fma_f32 v70, v22, v22, -v78
  v_mul_f32 v71, v79, v23
  v_mul_f32 v78, v71, v71
  v_add_f32 v79, v70, v70
  v_fma_f32 v72, v70, v70, -v78
  v_mul_f32 v73, v79, v71
  v_mul_f32 v78, v73, v73
  v_add_f32 v79, v72, v72
  v_fma_f32 v70, v72, v72, -v78
  v_mul_f32 v71, v79, v73
  v_mul_f32 v78, v71, v71
  v_add_f32 v79, v70, v70
  s_add_u32 m0, s94, 24576
  s_mul_i32 s16, s81, 1376
  buffer_load_dwordx4 v4, s[56:59], s16 offen lds
  buffer_load_dwordx4 v5, s[56:59], s16 offen offset:1024 lds
  buffer_load_dwordx4 v6, s[56:59], s16 offen offset:2048 lds
  s_add_u32 m0, s94, 27648
  s_add_u32 s16, s16, 44032
  buffer_load_dwordx4 v4, s[56:59], s16 offen lds
  buffer_load_dwordx4 v5, s[56:59], s16 offen offset:1024 lds
  buffer_load_dwordx4 v6, s[56:59], s16 offen offset:2048 lds
  v_fma_f32 v26, v70, v70, -v78
  v_mul_f32 v27, v79, v71
  v_mul_f32 v78, v27, v27
  v_add_f32 v79, v26, v26
  v_fma_f32 v70, v26, v26, -v78
  v_mul_f32 v71, v79, v27
  v_mul_f32 v78, v71, v71
  v_add_f32 v79, v70, v70
  v_fma_f32 v72, v70, v70, -v78
  v_mul_f32 v73, v79, v71
  v_mul_f32 v78, v73, v73
  v_add_f32 v79, v72, v72
  v_fma_f32 v28, v72, v72, -v78
  v_mul_f32 v29, v79, v73
  v_mul_f32 v78, v29, v29
  v_add_f32 v79, v28, v28
  v_fma_f32 v30, v28, v28, -v78
  v_mul_f32 v31, v79, v29
  v_mov_b32 v32, v24
  v_mov_b32 v33, v25
  v_and_b32 v74, 8, v1
  v_cmp_ne_u32 vcc, 0, v74
  s_nop 1
  v_cndmask_b32 v76, 1.0, v26, vcc
  v_cndmask_b32 v77, 0, v27, vcc
  v_mul_f32 v78, v32, v76
  v_mul_f32 v79, v32, v77
  v_fma_f32 v78, -v33, v77, v78
  v_fma_f32 v33, v33, v76, v79
  v_mov_b32 v32, v78
  v_and_b32 v74, 16, v1
  v_cmp_ne_u32 vcc, 0, v74
  s_nop 1
  v_cndmask_b32 v76, 1.0, v70, vcc
  v_cndmask_b32 v77, 0, v71, vcc
  v_mul_f32 v78, v32, v76
  v_mul_f32 v79, v32, v77
  v_fma_f32 v78, -v33, v77, v78
  v_fma_f32 v33, v33, v76, v79
  v_mov_b32 v32, v78
  v_and_b32 v74, 32, v1
  v_cmp_ne_u32 vcc, 0, v74
  s_nop 1
  v_cndmask_b32 v76, 1.0, v72, vcc
  v_cndmask_b32 v77, 0, v73, vcc
  v_mul_f32 v78, v32, v76
  v_mul_f32 v79, v32, v77
  v_fma_f32 v78, -v33, v77, v78
  v_fma_f32 v33, v33, v76, v79
  v_mov_b32 v32, v78
  v_and_b32 v74, 8, v1
  v_cmp_eq_u32 vcc, 0, v74
  s_nop 1
  v_cndmask_b32 v56, 1.0, v26, vcc
  v_cndmask_b32 v57, 0, v27, vcc
  v_and_b32 v74, 16, v1
  v_cmp_eq_u32 vcc, 0, v74
  s_nop 1
  v_cndmask_b32 v76, 1.0, v70, vcc
  v_cndmask_b32 v77, 0, v71, vcc
  v_mul_f32 v78, v56, v76
  v_mul_f32 v79, v56, v77
  v_fma_f32 v78, -v57, v77, v78
  v_fma_f32 v57, v57, v76, v79
  v_mov_b32 v56, v78
  v_and_b32 v74, 32, v1
  v_cmp_eq_u32 vcc, 0, v74
  s_nop 1
  v_cndmask_b32 v76, 1.0, v72, vcc
  v_cndmask_b32 v77, 0, v73, vcc
  v_mul_f32 v78, v56, v76
  v_mul_f32 v79, v56, v77
  v_fma_f32 v78, -v57, v77, v78
  v_fma_f32 v57, v57, v76, v79
  v_mov_b32 v56, v78
  v_mul_f32 v78, v31, v31
  v_add_f32 v79, v30, v30
  v_fma_f32 v70, v30, v30, -v78
  v_mul_f32 v71, v79, v31
  v_mul_f32 v78, v71, v71
  v_add_f32 v79, v70, v70
  v_fma_f32 v72, v70, v70, -v78
  v_mul_f32 v73, v79, v71
  v_and_b32 v74, 8, v1
  v_cmp_eq_u32 vcc, 0, v74
  s_nop 1
  v_cndmask_b32 v58, 1.0, v30, vcc
  v_cndmask_b32 v59, 0, v31, vcc
  v_and_b32 v74, 16, v1
  v_cmp_eq_u32 vcc, 0, v74
  s_nop 1
  v_cndmask_b32 v76, 1.0, v70, vcc
  v_cndmask_b32 v77, 0, v71, vcc
  v_mul_f32 v78, v58, v76
  v_mul_f32 v79, v58, v77
  v_fma_f32 v78, -v59, v77, v78
  v_fma_f32 v59, v59, v76, v79
  v_mov_b32 v58, v78
  v_and_b32 v74, 32, v1
  v_cmp_eq_u32 vcc, 0, v74
  s_nop 1
  v_cndmask_b32 v76, 1.0, v72, vcc
  v_cndmask_b32 v77, 0, v73, vcc
  v_mul_f32 v78, v58, v76
  v_mul_f32 v79, v58, v77
  v_fma_f32 v78, -v59, v77, v78
  v_fma_f32 v59, v59, v76, v79
  v_mov_b32 v58, v78
  s_waitcnt vmcnt(6)
  v_mov_b32 v162, 5
  ds_write_b32 v163, v162 offset:16
L_spin17:
  ds_read_b32 v161, v160 offset:0
  s_sub_u32 s99, s99, 1
  s_cbranch_scc1 L_end
  s_waitcnt lgkmcnt(0)
  v_cmp_gt_u32 vcc, 3, v161
  s_cbranch_vccnz L_spin17
  s_add_u32 m0, s94, 49152
  s_mul_i32 s16, s82, 1376
  buffer_load_dwordx4 v4, s[56:59], s16 offen lds
  buffer_load_dwordx4 v5, s[56:59], s16 offen offset:1024 lds
  buffer_load_dwordx4 v6, s[56:59], s16 offen offset:2048 lds
  s_add_u32 m0, s94, 52224
  s_add_u32 s16, s16, 44032
  buffer_load_dwordx4 v4, s[56:59], s16 offen lds
  buffer_load_dwordx4 v5, s[56:59], s16 offen offset:1024 lds
  buffer_load_dwordx4 v6, s[56:59], s16 offen offset:2048 lds
  s_waitcnt vmcnt(6)
  v_mov_b32 v162, 6
  ds_write_b32 v163, v162 offset:16
  s_add_u32 m0, s94, 73728
  s_mul_i32 s16, s83, 1376
  buffer_load_dwordx4 v4, s[56:59], s16 offen lds
  buffer_load_dwordx4 v5, s[56:59], s16 offen offset:1024 lds
  buffer_load_dwordx4 v6, s[56:59], s16 offen offset:2048 lds
  s_add_u32 m0, s94, 76800
  s_add_u32 s16, s16, 44032
  buffer_load_dwordx4 v4, s[56:59], s16 offen lds
  buffer_load_dwordx4 v5, s[56:59], s16 offen offset:1024 lds
  buffer_load_dwordx4 v6, s[56:59], s16 offen offset:2048 lds
  s_and_b32 s10, s3, 1
  v_lshlrev_b32 v86, 4, v82
  v_lshl_add_u32 v86, v81, 10, v86
  v_and_b32 v87, 16, v1
  v_lshlrev_b32 v87, 2, v87
  v_xor_b32 v87, v86, v87
  s_lshl_b32 s12, s6, 7
  v_add_u32 v12, s12, v87
  v_add_u32 v13, 7168, v12
  v_add_u32 v14, 14336, v12
  v_add_u32 v15, 21504, v12
  s_lshl1_add_u32 s13, s4, s7
  s_lshl2_add_u32 s9, s13, s3
  s_lshl_b32 s9, s9, 14
  s_add_u32 s9, s9, s12
  v_add_u32 v17, s9, v86
  v_add_u32 v18, 7168, v17
  s_lshr_b32 s11, s3, 1
  s_lshl1_add_u32 s9, s13, s11
  s_mul_i32 s9, s9, 163840
  s_lshl_b32 s12, s10, 12
  s_add_u32 s9, s9, s12
  v_lshl_add_u32 v16, v1, 4, s9
  s_cmp_eq_u32 s3, 0
  s_cselect_b32 s11, 8, 0
  v_cmp_gt_u32 vcc, s11, v1
  s_lshl1_add_u32 s9, s4, s7
  s_lshl_b32 s9, s9, 10
  s_lshl2_add_u32 s12, s6, s9
  v_lshl_add_u32 v86, v1, 7, s12
  v_cndmask_b32 v19, v90, v86, vcc
  s_mov_b32 s20, 10747904
  s_mov_b32 s21, 10780672
  v_readfirstlane_b32 s90, v21
  s_nop 1
  s_cmp_eq_u32 s90, 0
  s_cbranch_scc1 L_slow_tagH
L_back_tagH:
  s_mov_b32 s74, s90
  s_mov_b32 s75, s90
  v_mov_b32 v61, s90
  v_mov_b32 v63, s90
  v_and_b32 v44, s90, v44
  v_and_b32 v45, s90, v45
  v_lshl_add_u32 v76, v1, 4, s88
  ds_write_b64 v92, v[8:9] offset:1024
  ds_write_b32 v92, v12 offset:1032
  ds_write_b32 v92, v61 offset:1036
  s_add_u32 s95, s6, s101
  s_mul_i32 s52, s7, 49152
  s_add_u32 s52, s52, 65536
  s_add_u32 s17, s95, 0
  s_and_b32 s17, s17, 3
  s_lshl2_add_u32 s17, s7, s17
  s_lshl_b32 s17, s17, 7
  buffer_load_dwordx4 v[168:171], v8, s[60:63], s17 offen
  buffer_load_dwordx4 v[172:175], v9, s[60:63], s17 offen offset:1024
  buffer_load_dwordx4 v[176:179], v10, s[60:63], s17 offen offset:2048
  buffer_load_dwordx4 v[180:183], v11, s[60:63], s17 offen offset:3072
  s_add_u32 s100, s95, 0
  s_and_b32 s100, s100, 3
  s_lshl2_add_u32 s100, s100, s3
  s_and_b32 s18, s100, 7
  s_lshl3_add_u32 s18, s7, s18
  s_mul_i32 s18, s18, 3
  s_lshr_b32 s100, s100, 3
  s_add_u32 s18, s18, s100
  s_sub_u32 s100, s18, 22
  s_cmp_lt_u32 s100, 2
  s_cselect_b32 s18, 64, s18
  s_lshl_b32 s100, s7, 1
  s_sub_u32 s18, s18, s100
  s_lshl_b32 s18, s18, 15
  buffer_load_dwordx4 v[184:187], v12, s[64:67], s18 offen
  buffer_load_dwordx4 v[188:191], v13, s[64:67], s18 offen offset:1024
  buffer_load_dwordx4 v[192:195], v14, s[64:67], s18 offen offset:2048
  buffer_load_dwordx4 v[196:199], v15, s[64:67], s18 offen offset:3072
  s_setprio 0
L_spin18:
  ds_read_b32 v161, v160 offset:0
  s_sub_u32 s99, s99, 1
  s_cbranch_scc1 L_end
  s_waitcnt lgkmcnt(0)
  v_cmp_gt_u32 vcc, 5, v161
  s_cbranch_vccnz L_spin18
  ds_read_b128 v[128:131], v54 offset:0
  ds_read_b128 v[96:99], v164 offset:32768
  ds_read_b128 v[112:115], v164 offset:0
  ds_read_b128 v[132:135], v54 offset:16
  ds_read_b128 v[100:103], v165 offset:32768
  ds_read_b128 v[116:119], v165 offset:0
  ds_read_b128 v[136:139], v54 offset:32
  ds_read_b128 v[104:107], v166 offset:32768
  ds_read_b128 v[120:123], v166 offset:0
  ds_read_b128 v[140:143], v54 offset:48
  ds_read_b128 v[108:111], v167 offset:32768
  ds_read_b128 v[124:127], v167 offset:0
  s_waitcnt lgkmcnt(9)
  v_mul_f32 v96, v96, v128
  v_mul_f32_e64 v112, -v112, v128
  v_mul_f32 v97, v97, v129
  v_mul_f32_e64 v113, -v113, v129
  s_waitcnt lgkmcnt(0)
  s_waitcnt vmcnt(14)
  v_mov_b32 v162, 7
  ds_write_b32 v163, v162 offset:16
  v_fma_f32 v36, v22, v96, v97
  v_fma_f32 v37, v22, v112, v113
  v_fma_f32 v36, -v23, v112, v36
  v_fma_f32 v37, v23, v96, v37
  v_mul_f32 v98, v98, v130
  v_mul_f32_e64 v114, -v114, v130
  v_fma_f32 v34, v22, v36, v98
  v_fma_f32 v35, v22, v37, v114
  v_fma_f32 v34, -v23, v37, v34
  v_fma_f32 v35, v23, v36, v35
  v_mul_f32 v99, v99, v131
  v_mul_f32_e64 v115, -v115, v131
  v_fma_f32 v36, v22, v34, v99
  v_fma_f32 v37, v22, v35, v115
  v_fma_f32 v36, -v23, v35, v36
  v_fma_f32 v37, v23, v34, v37
  v_mul_f32 v100, v100, v132
  v_mul_f32_e64 v116, -v116, v132
  v_fma_f32 v34, v22, v36, v100
  v_fma_f32 v35, v22, v37, v116
  v_fma_f32 v34, -v23, v37, v34
  v_fma_f32 v35, v23, v36, v35
  v_mul_f32 v101, v101, v133
  v_mul_f32_e64 v117, -v117, v133
  v_fma_f32 v36, v22, v34, v101
  v_fma_f32 v37, v22, v35, v117
  v_fma_f32 v36, -v23, v35, v36
  v_fma_f32 v37, v23, v34, v37
  v_mul_f32 v102, v102, v134
  v_mul_f32_e64 v118, -v118, v134
  v_fma_f32 v34, v22, v36, v102
  v_fma_f32 v35, v22, v37, v118
  v_fma_f32 v34, -v23, v37, v34
  v_fma_f32 v35, v23, v36, v35
  v_mul_f32 v103, v103, v135
  v_mul_f32_e64 v119, -v119, v135
  v_fma_f32 v36, v22, v34, v103
  v_fma_f32 v37, v22, v35, v119
  v_fma_f32 v36, -v23, v35, v36
  v_fma_f32 v37, v23, v34, v37
  v_mul_f32 v104, v104, v136
  v_mul_f32_e64 v120, -v120, v136
  v_fma_f32 v34, v22, v36, v104
  v_fma_f32 v35, v22, v37, v120
  v_fma_f32 v34, -v23, v37, v34
  v_fma_f32 v35, v23, v36, v35
  v_mul_f32 v105, v105, v137
  v_mul_f32_e64 v121, -v121, v137
  v_fma_f32 v36, v22, v34, v105
  v_fma_f32 v37, v22, v35, v121
  v_fma_f32 v36, -v23, v35, v36
  v_fma_f32 v37, v23, v34, v37
  v_mul_f32 v106, v106, v138
  v_mul_f32_e64 v122, -v122, v138
  v_fma_f32 v34, v22, v36, v106
  v_fma_f32 v35, v22, v37, v122
  v_fma_f32 v34, -v23, v37, v34
  v_fma_f32 v35, v23, v36, v35
  v_mul_f32 v107, v107, v139
  v_mul_f32_e64 v123, -v123, v139
  v_fma_f32 v36, v22, v34, v107
  v_fma_f32 v37, v22, v35, v123
  v_fma_f32 v36, -v23, v35, v36
  v_fma_f32 v37, v23, v34, v37
  v_mul_f32 v108, v108, v140
  v_mul_f32_e64 v124, -v124, v140
  v_fma_f32 v34, v22, v36, v108
  v_fma_f32 v35, v22, v37, v124
  v_fma_f32 v34, -v23, v37, v34
  v_fma_f32 v35, v23, v36, v35
  v_mul_f32 v109, v109, v141
  v_mul_f32_e64 v125, -v125, v141
  v_fma_f32 v36, v22, v34, v109
  v_fma_f32 v37, v22, v35, v125
  v_fma_f32 v36, -v23, v35, v36
  v_fma_f32 v37, v23, v34, v37
  v_mul_f32 v110, v110, v142
  v_mul_f32_e64 v126, -v126, v142
  v_fma_f32 v34, v22, v36, v110
  v_fma_f32 v35, v22, v37, v126
  v_fma_f32 v34, -v23, v37, v34
  v_fma_f32 v35, v23, v36, v35
  v_mul_f32 v111, v111, v143
  v_mul_f32_e64 v127, -v127, v143
  v_fma_f32 v36, v22, v34, v111
  v_fma_f32 v37, v22, v35, v127
  v_fma_f32 v36, -v23, v35, v36
  v_fma_f32 v37, v23, v34, v37
  v_mul_f32 v60, v36, v56
  v_mul_f32 v62, v36, v57
  v_fma_f32 v60, -v37, v57, v60
  v_fmac_f32 v62, v37, v56
  s_nop 0
  v_add_f32_dpp v64, v60, v60 row_ror:8 row_mask:0xf bank_mask:0xf
  v_add_f32_dpp v65, v62, v62 row_ror:8 row_mask:0xf bank_mask:0xf
  v_mov_b32 v60, v64
  v_mov_b32 v62, v65
  s_nop 0
  v_permlane16_swap_b32 v60, v64
  v_permlane16_swap_b32 v62, v65
  v_add_f32 v60, v60, v64
  v_add_f32 v62, v62, v65
  s_waitcnt vmcnt(8)
  v_mov_b32 v162, 8
  ds_write_b32 v163, v162 offset:16
  v_mov_b32 v64, v60
  v_mov_b32 v65, v62
  s_nop 0
  v_permlane32_swap_b32 v60, v64
  v_permlane32_swap_b32 v62, v65
  v_add_f32 v60, v60, v64
  v_add_f32 v62, v62, v65
  buffer_store_dwordx4 v[60:63], v41, s[68:71], 0 offen sc1
  ds_write_b64 v40, v[36:37] offset:448
  ds_read_b64 v[144:145], v40 offset:0
  ds_read_b64 v[146:147], v40 offset:64
  ds_read_b64 v[148:149], v40 offset:128
  ds_read_b64 v[150:151], v40 offset:192
  ds_read_b64 v[152:153], v40 offset:256
  ds_read_b64 v[154:155], v40 offset:320
  ds_read_b64 v[156:157], v40 offset:384
  v_mul_f32 v72, v25, v112
  v_mul_f32 v112, v24, v112
  v_fmac_f32 v112, v25, v96
  v_fma_f32 v96, v24, v96, -v72
  v_mul_f32 v72, v25, v113
  v_mul_f32 v113, v24, v113
  v_fmac_f32 v113, v25, v97
  v_fma_f32 v97, v24, v97, -v72
  v_mul_f32 v72, v25, v114
  v_mul_f32 v114, v24, v114
  v_fmac_f32 v114, v25, v98
  v_fma_f32 v98, v24, v98, -v72
  v_mul_f32 v72, v25, v115
  v_mul_f32 v115, v24, v115
  v_fmac_f32 v115, v25, v99
  v_fma_f32 v99, v24, v99, -v72
  v_mul_f32 v72, v25, v116
  v_mul_f32 v116, v24, v116
  v_fmac_f32 v116, v25, v100
  v_fma_f32 v100, v24, v100, -v72
  v_mul_f32 v72, v25, v117
  v_mul_f32 v117, v24, v117
  v_fmac_f32 v117, v25, v101
  v_fma_f32 v101, v24, v101, -v72
  v_mul_f32 v72, v25, v118
  v_mul_f32 v118, v24, v118
  v_fmac_f32 v118, v25, v102
  v_fma_f32 v102, v24, v102, -v72
  v_mul_f32 v72, v25, v119
  v_mul_f32 v119, v24, v119
  v_fmac_f32 v119, v25, v103
  v_fma_f32 v103, v24, v103, -v72
  v_mul_f32 v72, v25, v120
  v_mul_f32 v120, v24, v120
  v_fmac_f32 v120, v25, v104
  v_fma_f32 v104, v24, v104, -v72
  v_mul_f32 v72, v25, v121
  v_mul_f32 v121, v24, v121
  v_fmac_f32 v121, v25, v105
  v_fma_f32 v105, v24, v105, -v72
  v_mul_f32 v72, v25, v122
  v_mul_f32 v122, v24, v122
  v_fmac_f32 v122, v25, v106
  v_fma_f32 v106, v24, v106, -v72
  v_mul_f32 v72, v25, v123
  v_mul_f32 v123, v24, v123
  v_fmac_f32 v123, v25, v107
  v_fma_f32 v107, v24, v107, -v72
  v_mul_f32 v72, v25, v124
  v_mul_f32 v124, v24, v124
  v_fmac_f32 v124, v25, v108
  v_fma_f32 v108, v24, v108, -v72
  v_mul_f32 v72, v25, v125
  v_mul_f32 v125, v24, v125
  v_fmac_f32 v125, v25, v109
  v_fma_f32 v109, v24, v109, -v72
  v_mul_f32 v72, v25, v126
  v_mul_f32 v126, v24, v126
  v_fmac_f32 v126, v25, v110
  v_fma_f32 v110, v24, v110, -v72
  v_mul_f32 v72, v25, v127
  v_mul_f32 v127, v24, v127
  v_fmac_f32 v127, v25, v111
  v_fma_f32 v111, v24, v111, -v72
  s_waitcnt lgkmcnt(0)
  v_fma_f32 v34, v26, v144, v146
  v_fma_f32 v35, v26, v145, v147
  v_fma_f32 v34, -v27, v145, v34
  v_fma_f32 v35, v27, v144, v35
  v_fma_f32 v36, v26, v34, v148
  v_fma_f32 v37, v26, v35, v149
  v_fma_f32 v36, -v27, v35, v36
  v_fma_f32 v37, v27, v34, v37
  v_fma_f32 v34, v26, v36, v150
  v_fma_f32 v35, v26, v37, v151
  v_fma_f32 v34, -v27, v37, v34
  v_fma_f32 v35, v27, v36, v35
  v_fma_f32 v36, v26, v34, v152
  v_fma_f32 v37, v26, v35, v153
  v_fma_f32 v36, -v27, v35, v36
  v_fma_f32 v37, v27, v34, v37
  v_fma_f32 v34, v26, v36, v154
  v_fma_f32 v35, v26, v37, v155
  v_fma_f32 v34, -v27, v37, v34
  v_fma_f32 v35, v27, v36, v35
  v_fma_f32 v36, v26, v34, v156
  v_fma_f32 v37, v26, v35, v157
  v_fma_f32 v36, -v27, v35, v36
  v_fma_f32 v37, v27, v34, v37
  v_mul_f32 v38, v36, v24
  v_mul_f32 v39, v36, v25
  v_fma_f32 v38, -v37, v25, v38
  v_fmac_f32 v39, v37, v24
  buffer_load_dwordx4 v[64:67], v42, s[68:71], 0 offen sc1
  buffer_load_dwordx4 v[68:71], v43, s[68:71], 0 offen sc1
L_spin19:
  ds_read_b32 v161, v160 offset:0
  s_sub_u32 s99, s99, 1
  s_cbranch_scc1 L_end
  s_waitcnt lgkmcnt(0)
  v_cmp_gt_u32 vcc, 7, v161
  s_cbranch_vccnz L_spin19
  s_setprio 2
  s_waitcnt vmcnt(0)
  v_xor_b32 v72, v65, v44
  v_xor_b32 v73, v67, v44
  v_xor_b32 v74, v69, v45
  v_or3_b32 v72, v72, v73, v74
  v_xor_b32 v73, v71, v45
  v_or_b32 v72, v72, v73
  v_cmp_ne_u32 vcc, 0, v72
  s_cbranch_vccnz L_slow_e
L_back_e:
  v_fma_f32 v34, v28, v64, v68
  v_fma_f32 v35, v28, v66, v70
  v_fma_f32 v34, -v29, v66, v34
  v_fma_f32 v35, v29, v64, v35
  v_mul_f32 v36, v34, v58
  v_mul_f32 v37, v34, v59
  v_fma_f32 v36, -v35, v59, v36
  v_fmac_f32 v37, v35, v58
  s_nop 0
  v_add_f32_dpp v72, v36, v36 row_ror:8 row_mask:0xf bank_mask:0xf
  v_add_f32_dpp v73, v37, v37 row_ror:8 row_mask:0xf bank_mask:0xf
  v_mov_b32 v36, v72
  v_mov_b32 v37, v73
  s_nop 0
  v_permlane16_swap_b32 v36, v72
  v_permlane16_swap_b32 v37, v73
  v_add_f32 v36, v36, v72
  v_add_f32 v37, v37, v73
  v_mov_b32 v72, v36
  v_mov_b32 v73, v37
  s_nop 0
  v_permlane32_swap_b32 v36, v72
  v_permlane32_swap_b32 v37, v73
  v_add_f32 v36, v36, v72
  v_add_f32 v37, v37, v73
  v_fma_f32 v34, v32, v36, v38
  v_fma_f32 v35, v32, v37, v39
  v_fma_f32 v34, -v33, v37, v34
  v_fma_f32 v35, v33, v36, v35
  v_fma_f32 v96, v22, v34, v96
  v_fma_f32 v112, v22, v35, v112
  v_fma_f32 v96, -v23, v35, v96
  v_fma_f32 v112, v23, v34, v112
  v_fma_f32 v97, v22, v96, v97
  v_fma_f32 v113, v22, v112, v113
  v_fma_f32 v97, -v23, v112, v97
  v_fma_f32 v113, v23, v96, v113
  v_cvt_pk_bf16_f32 v144, v96, v97
  v_cvt_pk_bf16_f32 v152, v112, v113
  v_fma_f32 v98, v22, v97, v98
  v_fma_f32 v114, v22, v113, v114
  v_fma_f32 v98, -v23, v113, v98
  v_fma_f32 v114, v23, v97, v114
  v_fma_f32 v99, v22, v98, v99
  v_fma_f32 v115, v22, v114, v115
  v_fma_f32 v99, -v23, v114, v99
  v_fma_f32 v115, v23, v98, v115
  v_cvt_pk_bf16_f32 v145, v98, v99
  v_cvt_pk_bf16_f32 v153, v114, v115
  v_fma_f32 v100, v22, v99, v100
  v_fma_f32 v116, v22, v115, v116
  v_fma_f32 v100, -v23, v115, v100
  v_fma_f32 v116, v23, v99, v116
  v_fma_f32 v101, v22, v100, v101
  v_fma_f32 v117, v22, v116, v117
  v_fma_f32 v101, -v23, v116, v101
  v_fma_f32 v117, v23, v100, v117
  v_cvt_pk_bf16_f32 v146, v100, v101
  v_cvt_pk_bf16_f32 v154, v116, v117
  v_fma_f32 v102, v22, v101, v102
  v_fma_f32 v118, v22, v117, v118
  v_fma_f32 v102, -v23, v117, v102
  v_fma_f32 v118, v23, v101, v118
  v_fma_f32 v103, v22, v102, v103
  v_fma_f32 v119, v22, v118, v119
  v_fma_f32 v103, -v23, v118, v103
  v_fma_f32 v119, v23, v102, v119
  v_cvt_pk_bf16_f32 v147, v102, v103
  v_cvt_pk_bf16_f32 v155, v118, v119
  v_fma_f32 v104, v22, v103, v104
  v_fma_f32 v120, v22, v119, v120
  v_fma_f32 v104, -v23, v119, v104
  v_fma_f32 v120, v23, v103, v120
  v_fma_f32 v105, v22, v104, v105
  v_fma_f32 v121, v22, v120, v121
  v_fma_f32 v105, -v23, v120, v105
  v_fma_f32 v121, v23, v104, v121
  v_cvt_pk_bf16_f32 v148, v104, v105
  v_cvt_pk_bf16_f32 v156, v120, v121
  v_fma_f32 v106, v22, v105, v106
  v_fma_f32 v122, v22, v121, v122
  v_fma_f32 v106, -v23, v121, v106
  v_fma_f32 v122, v23, v105, v122
  v_fma_f32 v107, v22, v106, v107
  v_fma_f32 v123, v22, v122, v123
  v_fma_f32 v107, -v23, v122, v107
  v_fma_f32 v123, v23, v106, v123
  v_cvt_pk_bf16_f32 v149, v106, v107
  v_cvt_pk_bf16_f32 v157, v122, v123
  v_fma_f32 v108, v22, v107, v108
  v_fma_f32 v124, v22, v123, v124
  v_fma_f32 v108, -v23, v123, v108
  v_fma_f32 v124, v23, v107, v124
  v_fma_f32 v109, v22, v108, v109
  v_fma_f32 v125, v22, v124, v125
  v_fma_f32 v109, -v23, v124, v109
  v_fma_f32 v125, v23, v108, v125
  v_cvt_pk_bf16_f32 v150, v108, v109
  v_cvt_pk_bf16_f32 v158, v124, v125
  v_fma_f32 v110, v22, v109, v110
  v_fma_f32 v126, v22, v125, v126
  v_fma_f32 v110, -v23, v125, v110
  v_fma_f32 v126, v23, v109, v126
  v_fma_f32 v111, v22, v110, v111
  v_fma_f32 v127, v22, v126, v127
  v_fma_f32 v111, -v23, v126, v111
  v_fma_f32 v127, v23, v110, v127
  v_cvt_pk_bf16_f32 v151, v110, v111
  v_cvt_pk_bf16_f32 v159, v126, v127
  ds_write_b128 v47, v[144:147] offset:0
  ds_write_b128 v47, v[148:151] offset:16
  ds_read_b64_tr_b16 v[128:129], v48 offset:0
  ds_read_b64_tr_b16 v[130:131], v48 offset:1344
  ds_read_b64_tr_b16 v[132:133], v48 offset:128
  ds_read_b64_tr_b16 v[134:135], v48 offset:1472
  ds_write_b128 v47, v[152:155] offset:0
  ds_write_b128 v47, v[156:159] offset:16
  ds_read_b64_tr_b16 v[136:137], v48 offset:0
  ds_read_b64_tr_b16 v[138:139], v48 offset:1344
  ds_read_b64_tr_b16 v[140:141], v48 offset:128
  ds_read_b64_tr_b16 v[142:143], v48 offset:1472
  s_mov_b32 s9, 0
  s_waitcnt lgkmcnt(8)
  buffer_store_dwordx4 v[128:131], v49, s[68:71], s9 offen sc1
  s_mov_b32 s9, 327680
  s_waitcnt lgkmcnt(6)
  buffer_store_dwordx4 v[132:135], v49, s[68:71], s9 offen sc1
  s_mov_b32 s9, 4096
  s_waitcnt lgkmcnt(2)
  buffer_store_dwordx4 v[136:139], v49, s[68:71], s9 offen sc1
  s_mov_b32 s9, 331776
  s_waitcnt lgkmcnt(0)
  buffer_store_dwordx4 v[140:143], v49, s[68:71], s9 offen sc1
  s_waitcnt vmcnt(0)
  v_mov_b32 v162, 2
  ds_write_b32 v163, v162 offset:32
L_spin20:
  ds_read_b32 v161, v160 offset:32
  s_sub_u32 s99, s99, 1
  s_cbranch_scc1 L_end
  s_waitcnt lgkmcnt(0)
  v_cmp_gt_u32 vcc, 2, v161
  s_cbranch_vccnz L_spin20
  buffer_store_dword v61, v19, s[68:71], s20 offen sc1
  s_add_u32 m0, s89, 152576
  s_nop 0
  buffer_load_dwordx4 v17, s[48:51], 0 offen lds
  buffer_load_dwordx4 v18, s[48:51], 0 offen offset:1024 lds
  s_add_u32 s100, s95, 4
  s_and_b32 s100, s100, 1
  s_add_u32 s100, s100, 4
  s_lshl2_add_u32 s100, s100, s3
  s_and_b32 s18, s100, 7
  s_lshl3_add_u32 s18, s7, s18
  s_mul_i32 s18, s18, 3
  s_lshr_b32 s100, s100, 3
  s_add_u32 s18, s18, s100
  s_sub_u32 s100, s18, 22
  s_cmp_lt_u32 s100, 2
  s_cselect_b32 s18, 64, s18
  s_lshl_b32 s100, s7, 1
  s_sub_u32 s18, s18, s100
  s_lshl_b32 s18, s18, 15
  buffer_load_dwordx4 v[200:203], v12, s[64:67], s18 offen
  buffer_load_dwordx4 v[204:207], v13, s[64:67], s18 offen offset:1024
  buffer_load_dwordx4 v[208:211], v14, s[64:67], s18 offen offset:2048
  buffer_load_dwordx4 v[212:215], v15, s[64:67], s18 offen offset:3072
  s_waitcnt vmcnt(4)
  v_mov_b32 v162, 9
  ds_write_b32 v163, v162 offset:16
  s_setprio 2
L_spin21:
  ds_read_b32 v161, v160 offset:0
  s_sub_u32 s99, s99, 1
  s_cbranch_scc1 L_end
  s_waitcnt lgkmcnt(0)
  v_cmp_gt_u32 vcc, 12, v161
  s_cbranch_vccnz L_spin21
  s_waitcnt lgkmcnt(0)
  s_cmp_lg_u32 s3, 0
  s_cbranch_scc1 L_back_ph
L_poll_ph:
  s_load_dwordx8 s[40:47], s[72:73], 0 glc
  s_sub_u32 s99, s99, 8
  s_cbranch_scc1 L_end
  s_waitcnt lgkmcnt(0)
  s_xor_b64 s[40:41], s[40:41], s[74:75]
  s_xor_b64 s[42:43], s[42:43], s[74:75]
  s_xor_b64 s[44:45], s[44:45], s[74:75]
  s_xor_b64 s[46:47], s[46:47], s[74:75]
  s_or_b64 s[40:41], s[40:41], s[42:43]
  s_or_b64 s[44:45], s[44:45], s[46:47]
  s_or_b64 s[40:41], s[40:41], s[44:45]
  s_cbranch_scc1 L_poll_ph
L_back_ph:
  v_mov_b32 v162, 10
  ds_write_b32 v163, v162 offset:16
  s_mov_b32 s19, 10813440
L_spin22:
  ds_read_b32 v161, v160 offset:0
  s_sub_u32 s99, s99, 1
  s_cbranch_scc1 L_end
  s_waitcnt lgkmcnt(0)
  v_cmp_gt_u32 vcc, 13, v161
  s_cbranch_vccnz L_spin22
  v_add_u32 v77, 98304, v76
  ds_write_b128 v77, v[168:171] offset:0
  ds_write_b128 v77, v[172:175] offset:1024
  ds_write_b128 v77, v[176:179] offset:2048
  ds_write_b128 v77, v[180:183] offset:3072
  s_setprio 2
L_spin23:
  ds_read_b32 v161, v160 offset:0
  s_sub_u32 s99, s99, 1
  s_cbranch_scc1 L_end
  s_waitcnt lgkmcnt(0)
  v_cmp_gt_u32 vcc, 14, v161
  s_cbranch_vccnz L_spin23
  buffer_store_dword v61, v19, s[68:71], s19 offen sc1
  s_setprio 2
  v_add_u32 v77, 114688, v76
  ds_write_b128 v77, v[184:187] offset:0
  ds_write_b128 v77, v[188:191] offset:1024
  ds_write_b128 v77, v[192:195] offset:2048
  ds_write_b128 v77, v[196:199] offset:3072
  s_barrier
  s_waitcnt lgkmcnt(0)
  s_cmp_lg_u32 s3, 0
  s_cbranch_scc1 L_back_pa
L_poll_pa:
  s_load_dwordx8 s[40:47], s[72:73], 65536 glc
  s_sub_u32 s99, s99, 8
  s_cbranch_scc1 L_end
  s_waitcnt lgkmcnt(0)
  s_xor_b64 s[40:41], s[40:41], s[74:75]
  s_xor_b64 s[42:43], s[42:43], s[74:75]
  s_xor_b64 s[44:45], s[44:45], s[74:75]
  s_xor_b64 s[46:47], s[46:47], s[74:75]
  s_or_b64 s[40:41], s[40:41], s[42:43]
  s_or_b64 s[44:45], s[44:45], s[46:47]
  s_or_b64 s[40:41], s[40:41], s[44:45]
  s_cbranch_scc1 L_poll_pa
L_back_pa:
  v_mov_b32 v162, 11
  ds_write_b32 v163, v162 offset:16
  s_setprio 2
L_spin24:
  ds_read_b32 v161, v160 offset:0
  s_sub_u32 s99, s99, 1
  s_cbranch_scc1 L_end
  s_waitcnt lgkmcnt(0)
  v_cmp_gt_u32 vcc, 15, v161
  s_cbranch_vccnz L_spin24
  buffer_store_dword v61, v19, s[68:71], s21 offen sc1
  s_setprio 2
  s_add_u32 m0, s88, 16384
  s_add_u32 s100, s95, 2
  s_and_b32 s100, s100, 3
  s_lshl2_add_u32 s100, s100, s3
  s_and_b32 s18, s100, 7
  s_lshl3_add_u32 s18, s7, s18
  s_mul_i32 s18, s18, 3
  s_lshr_b32 s100, s100, 3
  s_add_u32 s18, s18, s100
  s_sub_u32 s100, s18, 22
  s_cmp_lt_u32 s100, 2
  s_cselect_b32 s18, 64, s18
  s_lshl_b32 s100, s7, 1
  s_sub_u32 s18, s18, s100
  s_lshl_b32 s18, s18, 15
  buffer_load_dwordx4 v12, s[64:67], s18 offen lds
  buffer_load_dwordx4 v13, s[64:67], s18 offen offset:1024 lds
  buffer_load_dwordx4 v14, s[64:67], s18 offen offset:2048 lds
  buffer_load_dwordx4 v15, s[64:67], s18 offen offset:3072 lds
  s_add_u32 m0, s88, 32768
  s_add_u32 s100, s95, 3
  s_and_b32 s100, s100, 3
  s_lshl2_add_u32 s100, s100, s3
  s_and_b32 s18, s100, 7
  s_lshl3_add_u32 s18, s7, s18
  s_mul_i32 s18, s18, 3
  s_lshr_b32 s100, s100, 3
  s_add_u32 s18, s18, s100
  s_sub_u32 s100, s18, 22
  s_cmp_lt_u32 s100, 2
  s_cselect_b32 s18, 64, s18
  s_lshl_b32 s100, s7, 1
  s_sub_u32 s18, s18, s100
  s_lshl_b32 s18, s18, 15
  buffer_load_dwordx4 v12, s[64:67], s18 offen lds
  buffer_load_dwordx4 v13, s[64:67], s18 offen offset:1024 lds
  buffer_load_dwordx4 v14, s[64:67], s18 offen offset:2048 lds
  buffer_load_dwordx4 v15, s[64:67], s18 offen offset:3072 lds
  s_waitcnt lgkmcnt(0)
  s_cmp_lg_u32 s3, 0
  s_cbranch_scc1 L_back_pg
L_poll_pg:
  s_load_dwordx8 s[40:47], s[72:73], 32768 glc
  s_sub_u32 s99, s99, 8
  s_cbranch_scc1 L_end
  s_waitcnt lgkmcnt(0)
  s_xor_b64 s[40:41], s[40:41], s[74:75]
  s_xor_b64 s[42:43], s[42:43], s[74:75]
  s_xor_b64 s[44:45], s[44:45], s[74:75]
  s_xor_b64 s[46:47], s[46:47], s[74:75]
  s_or_b64 s[40:41], s[40:41], s[42:43]
  s_or_b64 s[44:45], s[44:45], s[46:47]
  s_or_b64 s[40:41], s[40:41], s[44:45]
  s_cbranch_scc1 L_poll_pg
L_back_pg:
  v_mov_b32 v162, 12
  ds_write_b32 v163, v162 offset:16
  s_waitcnt vmcnt(0)
  s_barrier
  s_add_u32 m0, s88, 49152
  s_add_u32 s100, s95, 5
  s_and_b32 s100, s100, 1
  s_add_u32 s100, s100, 4
  s_lshl2_add_u32 s100, s100, s3
  s_and_b32 s18, s100, 7
  s_lshl3_add_u32 s18, s7, s18
  s_mul_i32 s18, s18, 3
  s_lshr_b32 s100, s100, 3
  s_add_u32 s18, s18, s100
  s_sub_u32 s100, s18, 22
  s_cmp_lt_u32 s100, 2
  s_cselect_b32 s18, 64, s18
  s_lshl_b32 s100, s7, 1
  s_sub_u32 s18, s18, s100
  s_lshl_b32 s18, s18, 15
  buffer_load_dwordx4 v12, s[64:67], s18 offen lds
  buffer_load_dwordx4 v13, s[64:67], s18 offen offset:1024 lds
  buffer_load_dwordx4 v14, s[64:67], s18 offen offset:2048 lds
  buffer_load_dwordx4 v15, s[64:67], s18 offen offset:3072 lds
  v_add_u32 v77, 131072, v76
  ds_write_b128 v77, v[200:203] offset:0
  ds_write_b128 v77, v[204:207] offset:1024
  ds_write_b128 v77, v[208:211] offset:2048
  ds_write_b128 v77, v[212:215] offset:3072
  s_waitcnt vmcnt(0) lgkmcnt(0)
  s_barrier
  s_barrier
  s_barrier
  s_barrier
L_end:
  s_endpgm
L_cmain:
  v_and_b32 v90, 31, v1
  v_lshrrev_b32 v91, 5, v1
  v_bfe_u32 v92, v90, 1, 3
  v_xor_b32 v92, v92, v91
  v_lshlrev_b32 v92, 4, v92
  v_lshl_add_u32 v92, v90, 7, v92
  v_add_u32 v2, s88, v92
  v_xor_b32 v3, 32, v2
  v_xor_b32 v4, 64, v2
  v_xor_b32 v5, 96, v2
  s_mov_b32 s93, 0x3f803f80
  s_mov_b32 s91, 0x00003f80
  s_mov_b32 s92, 0x3f800000
  v_mov_b32 v64, 0
  v_mov_b32 v65, 0
  v_mov_b32 v66, 0
  v_mov_b32 v67, 0
  v_mov_b32 v68, 0
  v_mov_b32 v69, 0
  v_mov_b32 v70, 0
  v_mov_b32 v71, 0
  s_mov_b64 s[68:69], s[46:47]
  s_mov_b32 s70, 25165824
  s_mov_b32 s71, 0x20000
  s_mov_b64 s[72:73], s[42:43]
  s_mov_b32 s74, 4194304
  s_mov_b32 s75, 0x20000
  s_cmp_ge_u32 s3, 2
  s_cselect_b64 s[56:57], s[38:39], s[36:37]
  s_mov_b32 s58, 1409024
  s_mov_b32 s59, 0x20000
  s_cselect_b64 s[60:61], s[28:29], s[26:27]
  s_mov_b32 s62, 524288
  s_mov_b32 s63, 0x20000
  s_mul_i32 s94, s3, 6144
  s_mov_b64 s[64:65], s[40:41]
  s_mov_b32 s66, 1409024
  s_mov_b32 s67, 0x20000
  s_mov_b32 s97, 0
  s_mov_b32 s15, 0
  s_mov_b64 s[22:23], s[32:33]
  s_mov_b64 s[20:21], s[40:41]
  v_bfe_u32 v92, v1, 2, 2
  v_lshl_add_u32 v92, v91, 3, v92
  v_mul_u32_u24 v6, 192, v92
  v_and_b32 v93, 16, v1
  v_lshl_add_u32 v6, v93, 1, v6
  v_and_b32 v93, 1, v1
  v_lshl_add_u32 v6, v93, 4, v6
  v_and_b32 v93, 2, v1
  v_lshl_add_u32 v6, v93, 2, v6
  s_lshl_b32 s9, s3, 7
  s_add_u32 s9, s9, 147456
  v_bfe_u32 v93, v90, 2, 1
  v_lshlrev_b32 v94, 4, v93
  v_lshrrev_b32 v93, 3, v90
  v_lshl_add_u32 v94, v93, 2, v94
  v_and_b32 v93, 3, v90
  v_add_u32 v94, v94, v93
  v_lshl_add_u32 v94, v94, 2, s9
  v_and_b32 v72, 3, v1
  v_lshlrev_b32 v72, 2, v72
  v_add_u32 v72, 163328, v72
  s_lshl_b32 s9, s3, 2
  s_add_u32 s9, s9, 163328
  v_mov_b32 v75, s9
  s_waitcnt vmcnt(8)
  ds_read_b128 v[128:131], v2 offset:0
  ds_read_b128 v[132:135], v3 offset:0
  ds_read_b128 v[136:139], v4 offset:0
  ds_read_b128 v[140:143], v5 offset:0
  s_add_u32 m0, s88, 49152
  s_nop 0
  buffer_load_dwordx4 v86, s[48:51], s83 offen lds
  buffer_load_dwordx4 v87, s[48:51], s83 offen offset:1024 lds
  buffer_load_dwordx4 v88, s[48:51], s83 offen offset:2048 lds
  buffer_load_dwordx4 v89, s[48:51], s83 offen offset:3072 lds
  s_waitcnt lgkmcnt(3)
  v_dot2c_f32_bf16 v64, s93, v128
  v_dot2c_f32_bf16 v68, v128, v128
  v_dot2c_f32_bf16 v65, s93, v129
  v_dot2c_f32_bf16 v69, v129, v129
  v_dot2c_f32_bf16 v66, s93, v130
  v_dot2c_f32_bf16 v70, v130, v130
  v_dot2c_f32_bf16 v67, s93, v131
  v_dot2c_f32_bf16 v71, v131, v131
  s_waitcnt lgkmcnt(2)
  v_dot2c_f32_bf16 v64, s93, v132
  v_dot2c_f32_bf16 v68, v132, v132
  v_dot2c_f32_bf16 v65, s93, v133
  v_dot2c_f32_bf16 v69, v133, v133
  v_dot2c_f32_bf16 v66, s93, v134
  v_dot2c_f32_bf16 v70, v134, v134
  v_dot2c_f32_bf16 v67, s93, v135
  v_dot2c_f32_bf16 v71, v135, v135
  s_waitcnt lgkmcnt(1)
  v_dot2c_f32_bf16 v64, s93, v136
  v_dot2c_f32_bf16 v68, v136, v136
  v_dot2c_f32_bf16 v65, s93, v137
  v_dot2c_f32_bf16 v69, v137, v137
  v_dot2c_f32_bf16 v66, s93, v138
  v_dot2c_f32_bf16 v70, v138, v138
  v_dot2c_f32_bf16 v67, s93, v139
  v_dot2c_f32_bf16 v71, v139, v139
  s_waitcnt lgkmcnt(0)
  v_dot2c_f32_bf16 v64, s93, v140
  v_dot2c_f32_bf16 v68, v140, v140
  v_dot2c_f32_bf16 v65, s93, v141
  v_dot2c_f32_bf16 v69, v141, v141
  v_dot2c_f32_bf16 v66, s93, v142
  v_dot2c_f32_bf16 v70, v142, v142
  v_dot2c_f32_bf16 v67, s93, v143
  v_dot2c_f32_bf16 v71, v143, v143
  s_waitcnt vmcnt(8)
  ds_read_b128 v[144:147], v2 offset:16384
  ds_read_b128 v[148:151], v3 offset:16384
  ds_read_b128 v[152:155], v4 offset:16384
  ds_read_b128 v[156:159], v5 offset:16384
  s_add_u32 m0, s88, 0
  s_nop 0
  buffer_load_dwordx4 v86, s[48:51], s84 offen lds
  buffer_load_dwordx4 v87, s[48:51], s84 offen offset:1024 lds
  buffer_load_dwordx4 v88, s[48:51], s84 offen offset:2048 lds
  buffer_load_dwordx4 v89, s[48:51], s84 offen offset:3072 lds
  s_waitcnt lgkmcnt(3)
  v_dot2c_f32_bf16 v64, s93, v144
  v_dot2c_f32_bf16 v68, v144, v144
  v_dot2c_f32_bf16 v65, s93, v145
  v_dot2c_f32_bf16 v69, v145, v145
  v_dot2c_f32_bf16 v66, s93, v146
  v_dot2c_f32_bf16 v70, v146, v146
  v_dot2c_f32_bf16 v67, s93, v147
  v_dot2c_f32_bf16 v71, v147, v147
  s_waitcnt lgkmcnt(2)
  v_dot2c_f32_bf16 v64, s93, v148
  v_dot2c_f32_bf16 v68, v148, v148
  v_dot2c_f32_bf16 v65, s93, v149
  v_dot2c_f32_bf16 v69, v149, v149
  v_dot2c_f32_bf16 v66, s93, v150
  v_dot2c_f32_bf16 v70, v150, v150
  v_dot2c_f32_bf16 v67, s93, v151
  v_dot2c_f32_bf16 v71, v151, v151
  s_waitcnt lgkmcnt(1)
  v_dot2c_f32_bf16 v64, s93, v152
  v_dot2c_f32_bf16 v68, v152, v152
  v_dot2c_f32_bf16 v65, s93, v153
  v_dot2c_f32_bf16 v69, v153, v153
  v_dot2c_f32_bf16 v66, s93, v154
  v_dot2c_f32_bf16 v70, v154, v154
  v_dot2c_f32_bf16 v67, s93, v155
  v_dot2c_f32_bf16 v71, v155, v155
  s_waitcnt lgkmcnt(0)
  v_dot2c_f32_bf16 v64, s93, v156
  v_dot2c_f32_bf16 v68, v156, v156
  v_dot2c_f32_bf16 v65, s93, v157
  v_dot2c_f32_bf16 v69, v157, v157
  v_dot2c_f32_bf16 v66, s93, v158
  v_dot2c_f32_bf16 v70, v158, v158
  v_dot2c_f32_bf16 v67, s93, v159
  v_dot2c_f32_bf16 v71, v159, v159
  s_waitcnt vmcnt(8)
  ds_read_b128 v[160:163], v2 offset:32768
  ds_read_b128 v[164:167], v3 offset:32768
  ds_read_b128 v[168:171], v4 offset:32768
  ds_read_b128 v[172:175], v5 offset:32768
  s_add_u32 m0, s88, 16384
  s_nop 0
  buffer_load_dwordx4 v86, s[48:51], s85 offen lds
  buffer_load_dwordx4 v87, s[48:51], s85 offen offset:1024 lds
  buffer_load_dwordx4 v88, s[48:51], s85 offen offset:2048 lds
  buffer_load_dwordx4 v89, s[48:51], s85 offen offset:3072 lds
  s_waitcnt lgkmcnt(3)
  v_dot2c_f32_bf16 v64, s93, v160
  v_dot2c_f32_bf16 v68, v160, v160
  v_dot2c_f32_bf16 v65, s93, v161
  v_dot2c_f32_bf16 v69, v161, v161
  v_dot2c_f32_bf16 v66, s93, v162
  v_dot2c_f32_bf16 v70, v162, v162
  v_dot2c_f32_bf16 v67, s93, v163
  v_dot2c_f32_bf16 v71, v163, v163
  s_waitcnt lgkmcnt(2)
  v_dot2c_f32_bf16 v64, s93, v164
  v_dot2c_f32_bf16 v68, v164, v164
  v_dot2c_f32_bf16 v65, s93, v165
  v_dot2c_f32_bf16 v69, v165, v165
  v_dot2c_f32_bf16 v66, s93, v166
  v_dot2c_f32_bf16 v70, v166, v166
  v_dot2c_f32_bf16 v67, s93, v167
  v_dot2c_f32_bf16 v71, v167, v167
  s_waitcnt lgkmcnt(1)
  v_dot2c_f32_bf16 v64, s93, v168
  v_dot2c_f32_bf16 v68, v168, v168
  v_dot2c_f32_bf16 v65, s93, v169
  v_dot2c_f32_bf16 v69, v169, v169
  v_dot2c_f32_bf16 v66, s93, v170
  v_dot2c_f32_bf16 v70, v170, v170
  v_dot2c_f32_bf16 v67, s93, v171
  v_dot2c_f32_bf16 v71, v171, v171
  s_waitcnt lgkmcnt(0)
  v_dot2c_f32_bf16 v64, s93, v172
  v_dot2c_f32_bf16 v68, v172, v172
  v_dot2c_f32_bf16 v65, s93, v173
  v_dot2c_f32_bf16 v69, v173, v173
  v_dot2c_f32_bf16 v66, s93, v174
  v_dot2c_f32_bf16 v70, v174, v174
  v_dot2c_f32_bf16 v67, s93, v175
  v_dot2c_f32_bf16 v71, v175, v175
  s_waitcnt vmcnt(8)
  ds_read_b128 v[176:179], v2 offset:49152
  ds_read_b128 v[180:183], v3 offset:49152
  ds_read_b128 v[184:187], v4 offset:49152
  ds_read_b128 v[188:191], v5 offset:49152
  s_add_u32 m0, s88, 32768
  s_nop 0
  buffer_load_dwordx4 v86, s[48:51], s86 offen lds
  buffer_load_dwordx4 v87, s[48:51], s86 offen offset:1024 lds
  buffer_load_dwordx4 v88, s[48:51], s86 offen offset:2048 lds
  buffer_load_dwordx4 v89, s[48:51], s86 offen offset:3072 lds
  s_waitcnt lgkmcnt(3)
  v_dot2c_f32_bf16 v64, s93, v176
  v_dot2c_f32_bf16 v68, v176, v176
  v_dot2c_f32_bf16 v65, s93, v177
  v_dot2c_f32_bf16 v69, v177, v177
  v_dot2c_f32_bf16 v66, s93, v178
  v_dot2c_f32_bf16 v70, v178, v178
  v_dot2c_f32_bf16 v67, s93, v179
  v_dot2c_f32_bf16 v71, v179, v179
  s_waitcnt lgkmcnt(2)
  v_dot2c_f32_bf16 v64, s93, v180
  v_dot2c_f32_bf16 v68, v180, v180
  v_dot2c_f32_bf16 v65, s93, v181
  v_dot2c_f32_bf16 v69, v181, v181
  v_dot2c_f32_bf16 v66, s93, v182
  v_dot2c_f32_bf16 v70, v182, v182
  v_dot2c_f32_bf16 v67, s93, v183
  v_dot2c_f32_bf16 v71, v183, v183
  s_waitcnt lgkmcnt(1)
  v_dot2c_f32_bf16 v64, s93, v184
  v_dot2c_f32_bf16 v68, v184, v184
  v_dot2c_f32_bf16 v65, s93, v185
  v_dot2c_f32_bf16 v69, v185, v185
  v_dot2c_f32_bf16 v66, s93, v186
  v_dot2c_f32_bf16 v70, v186, v186
  v_dot2c_f32_bf16 v67, s93, v187
  v_dot2c_f32_bf16 v71, v187, v187
  s_waitcnt lgkmcnt(0)
  v_dot2c_f32_bf16 v64, s93, v188
  v_dot2c_f32_bf16 v68, v188, v188
  v_dot2c_f32_bf16 v65, s93, v189
  v_dot2c_f32_bf16 v69, v189, v189
  v_dot2c_f32_bf16 v66, s93, v190
  v_dot2c_f32_bf16 v70, v190, v190
  v_dot2c_f32_bf16 v67, s93, v191
  v_dot2c_f32_bf16 v71, v191, v191
  s_waitcnt vmcnt(8)
  ds_read_b128 v[192:195], v2 offset:0
  ds_read_b128 v[196:199], v3 offset:0
  ds_read_b128 v[200:203], v4 offset:0
  ds_read_b128 v[204:207], v5 offset:0
  s_add_u32 m0, s88, 49152
  s_nop 0
  buffer_load_dwordx4 v86, s[48:51], s87 offen lds
  buffer_load_dwordx4 v87, s[48:51], s87 offen offset:1024 lds
  buffer_load_dwordx4 v88, s[48:51], s87 offen offset:2048 lds
  buffer_load_dwordx4 v89, s[48:51], s87 offen offset:3072 lds
  s_waitcnt lgkmcnt(3)
  v_dot2c_f32_bf16 v64, s93, v192
  v_dot2c_f32_bf16 v68, v192, v192
  v_dot2c_f32_bf16 v65, s93, v193
  v_dot2c_f32_bf16 v69, v193, v193
  v_dot2c_f32_bf16 v66, s93, v194
  v_dot2c_f32_bf16 v70, v194, v194
  v_dot2c_f32_bf16 v67, s93, v195
  v_dot2c_f32_bf16 v71, v195, v195
  s_waitcnt lgkmcnt(2)
  v_dot2c_f32_bf16 v64, s93, v196
  v_dot2c_f32_bf16 v68, v196, v196
  v_dot2c_f32_bf16 v65, s93, v197
  v_dot2c_f32_bf16 v69, v197, v197
  v_dot2c_f32_bf16 v66, s93, v198
  v_dot2c_f32_bf16 v70, v198, v198
  v_dot2c_f32_bf16 v67, s93, v199
  v_dot2c_f32_bf16 v71, v199, v199
  s_waitcnt lgkmcnt(1)
  v_dot2c_f32_bf16 v64, s93, v200
  v_dot2c_f32_bf16 v68, v200, v200
  v_dot2c_f32_bf16 v65, s93, v201
  v_dot2c_f32_bf16 v69, v201, v201
  v_dot2c_f32_bf16 v66, s93, v202
  v_dot2c_f32_bf16 v70, v202, v202
  v_dot2c_f32_bf16 v67, s93, v203
  v_dot2c_f32_bf16 v71, v203, v203
  s_waitcnt lgkmcnt(0)
  v_dot2c_f32_bf16 v64, s93, v204
  v_dot2c_f32_bf16 v68, v204, v204
  v_dot2c_f32_bf16 v65, s93, v205
  v_dot2c_f32_bf16 v69, v205, v205
  v_dot2c_f32_bf16 v66, s93, v206
  v_dot2c_f32_bf16 v70, v206, v206
  v_dot2c_f32_bf16 v67, s93, v207
  v_dot2c_f32_bf16 v71, v207, v207
  s_waitcnt vmcnt(8)
  ds_read_b128 v[208:211], v2 offset:16384
  ds_read_b128 v[212:215], v3 offset:16384
  ds_read_b128 v[216:219], v4 offset:16384
  ds_read_b128 v[220:223], v5 offset:16384
  s_waitcnt lgkmcnt(3)
  v_dot2c_f32_bf16 v64, s93, v208
  v_dot2c_f32_bf16 v68, v208, v208
  v_dot2c_f32_bf16 v65, s93, v209
  v_dot2c_f32_bf16 v69, v209, v209
  v_dot2c_f32_bf16 v66, s93, v210
  v_dot2c_f32_bf16 v70, v210, v210
  v_dot2c_f32_bf16 v67, s93, v211
  v_dot2c_f32_bf16 v71, v211, v211
  s_waitcnt lgkmcnt(2)
  v_dot2c_f32_bf16 v64, s93, v212
  v_dot2c_f32_bf16 v68, v212, v212
  v_dot2c_f32_bf16 v65, s93, v213
  v_dot2c_f32_bf16 v69, v213, v213
  v_dot2c_f32_bf16 v66, s93, v214
  v_dot2c_f32_bf16 v70, v214, v214
  v_dot2c_f32_bf16 v67, s93, v215
  v_dot2c_f32_bf16 v71, v215, v215
  s_waitcnt lgkmcnt(1)
  v_dot2c_f32_bf16 v64, s93, v216
  v_dot2c_f32_bf16 v68, v216, v216
  v_dot2c_f32_bf16 v65, s93, v217
  v_dot2c_f32_bf16 v69, v217, v217
  v_dot2c_f32_bf16 v66, s93, v218
  v_dot2c_f32_bf16 v70, v218, v218
  v_dot2c_f32_bf16 v67, s93, v219
  v_dot2c_f32_bf16 v71, v219, v219
  s_waitcnt lgkmcnt(0)
  v_dot2c_f32_bf16 v64, s93, v220
  v_dot2c_f32_bf16 v68, v220, v220
  v_dot2c_f32_bf16 v65, s93, v221
  v_dot2c_f32_bf16 v69, v221, v221
  v_dot2c_f32_bf16 v66, s93, v222
  v_dot2c_f32_bf16 v70, v222, v222
  v_dot2c_f32_bf16 v67, s93, v223
  v_dot2c_f32_bf16 v71, v223, v223
  s_waitcnt vmcnt(4)
  ds_read_b128 v[224:227], v2 offset:32768
  ds_read_b128 v[228:231], v3 offset:32768
  ds_read_b128 v[232:235], v4 offset:32768
  ds_read_b128 v[236:239], v5 offset:32768
  s_waitcnt lgkmcnt(3)
  v_dot2c_f32_bf16 v64, s93, v224
  v_dot2c_f32_bf16 v68, v224, v224
  v_dot2c_f32_bf16 v65, s93, v225
  v_dot2c_f32_bf16 v69, v225, v225
  v_dot2c_f32_bf16 v66, s93, v226
  v_dot2c_f32_bf16 v70, v226, v226
  v_dot2c_f32_bf16 v67, s93, v227
  v_dot2c_f32_bf16 v71, v227, v227
  s_waitcnt lgkmcnt(2)
  v_dot2c_f32_bf16 v64, s93, v228
  v_dot2c_f32_bf16 v68, v228, v228
  v_dot2c_f32_bf16 v65, s93, v229
  v_dot2c_f32_bf16 v69, v229, v229
  v_dot2c_f32_bf16 v66, s93, v230
  v_dot2c_f32_bf16 v70, v230, v230
  v_dot2c_f32_bf16 v67, s93, v231
  v_dot2c_f32_bf16 v71, v231, v231
  s_waitcnt lgkmcnt(1)
  v_dot2c_f32_bf16 v64, s93, v232
  v_dot2c_f32_bf16 v68, v232, v232
  v_dot2c_f32_bf16 v65, s93, v233
  v_dot2c_f32_bf16 v69, v233, v233
  v_dot2c_f32_bf16 v66, s93, v234
  v_dot2c_f32_bf16 v70, v234, v234
  v_dot2c_f32_bf16 v67, s93, v235
  v_dot2c_f32_bf16 v71, v235, v235
  s_waitcnt lgkmcnt(0)
  v_dot2c_f32_bf16 v64, s93, v236
  v_dot2c_f32_bf16 v68, v236, v236
  v_dot2c_f32_bf16 v65, s93, v237
  v_dot2c_f32_bf16 v69, v237, v237
  v_dot2c_f32_bf16 v66, s93, v238
  v_dot2c_f32_bf16 v70, v238, v238
  v_dot2c_f32_bf16 v67, s93, v239
  v_dot2c_f32_bf16 v71, v239, v239
  s_waitcnt vmcnt(0)
  ds_read_b128 v[240:243], v2 offset:49152
  ds_read_b128 v[244:247], v3 offset:49152
  ds_read_b128 v[248:251], v4 offset:49152
  ds_read_b128 v[252:255], v5 offset:49152
  s_waitcnt lgkmcnt(3)
  v_dot2c_f32_bf16 v64, s93, v240
  v_dot2c_f32_bf16 v68, v240, v240
  v_dot2c_f32_bf16 v65, s93, v241
  v_dot2c_f32_bf16 v69, v241, v241
  v_dot2c_f32_bf16 v66, s93, v242
  v_dot2c_f32_bf16 v70, v242, v242
  v_dot2c_f32_bf16 v67, s93, v243
  v_dot2c_f32_bf16 v71, v243, v243
  s_waitcnt lgkmcnt(2)
  v_dot2c_f32_bf16 v64, s93, v244
  v_dot2c_f32_bf16 v68, v244, v244
  v_dot2c_f32_bf16 v65, s93, v245
  v_dot2c_f32_bf16 v69, v245, v245
  v_dot2c_f32_bf16 v66, s93, v246
  v_dot2c_f32_bf16 v70, v246, v246
  v_dot2c_f32_bf16 v67, s93, v247
  v_dot2c_f32_bf16 v71, v247, v247
  s_waitcnt lgkmcnt(1)
  v_dot2c_f32_bf16 v64, s93, v248
  v_dot2c_f32_bf16 v68, v248, v248
  v_dot2c_f32_bf16 v65, s93, v249
  v_dot2c_f32_bf16 v69, v249, v249
  v_dot2c_f32_bf16 v66, s93, v250
  v_dot2c_f32_bf16 v70, v250, v250
  v_dot2c_f32_bf16 v67, s93, v251
  v_dot2c_f32_bf16 v71, v251, v251
  s_waitcnt lgkmcnt(0)
  v_dot2c_f32_bf16 v64, s93, v252
  v_dot2c_f32_bf16 v68, v252, v252
  v_dot2c_f32_bf16 v65, s93, v253
  v_dot2c_f32_bf16 v69, v253, v253
  v_dot2c_f32_bf16 v66, s93, v254
  v_dot2c_f32_bf16 v70, v254, v254
  v_dot2c_f32_bf16 v67, s93, v255
  v_dot2c_f32_bf16 v71, v255, v255
  v_mov_b32 v74, 2
  ds_write_b32 v75, v74 offset:0
  ds_read_b32 v73, v72 offset:16
  v_add_f32 v64, v64, v65
  v_add_f32 v66, v66, v67
  v_add_f32 v68, v68, v69
  v_add_f32 v64, v64, v66
  v_add_f32 v70, v70, v71
  v_mov_b32 v65, v64
  v_add_f32 v68, v68, v70
  v_mov_b32 v69, v68
  v_permlane32_swap_b32 v64, v65
  s_nop 0
  v_permlane32_swap_b32 v68, v69
  v_add_f32 v64, v64, v65
  v_mul_f32 v64, 0x3b000000, v64
  v_cvt_pk_bf16_f32 v65, v64, v64
  v_and_b32 v65, 0xffff0000, v65
  v_sub_f32 v7, 0, v65
  s_sub_u32 s9, 65536, s88
  v_add_u32 v2, s9, v2
  v_add_u32 v3, s9, v3
  v_add_u32 v4, s9, v4
  v_add_u32 v5, s9, v5
  v_dot2_f32_bf16 v32, v128, s91, v7
  v_dot2_f32_bf16 v33, v128, s92, v7
  v_dot2_f32_bf16 v34, v129, s91, v7
  v_dot2_f32_bf16 v35, v129, s92, v7
  v_dot2_f32_bf16 v36, v130, s91, v7
  v_dot2_f32_bf16 v37, v130, s92, v7
  v_dot2_f32_bf16 v38, v131, s91, v7
  v_dot2_f32_bf16 v39, v131, s92, v7
  v_dot2_f32_bf16 v40, v132, s91, v7
  v_dot2_f32_bf16 v41, v132, s92, v7
  v_dot2_f32_bf16 v42, v133, s91, v7
  v_dot2_f32_bf16 v43, v133, s92, v7
  v_dot2_f32_bf16 v44, v134, s91, v7
  v_dot2_f32_bf16 v45, v134, s92, v7
  v_dot2_f32_bf16 v46, v135, s91, v7
  v_dot2_f32_bf16 v47, v135, s92, v7
  v_dot2_f32_bf16 v48, v136, s91, v7
  v_dot2_f32_bf16 v49, v136, s92, v7
  v_dot2_f32_bf16 v50, v137, s91, v7
  v_dot2_f32_bf16 v51, v137, s92, v7
  v_dot2_f32_bf16 v52, v138, s91, v7
  v_dot2_f32_bf16 v53, v138, s92, v7
  v_dot2_f32_bf16 v54, v139, s91, v7
  v_dot2_f32_bf16 v55, v139, s92, v7
  v_dot2_f32_bf16 v56, v140, s91, v7
  v_dot2_f32_bf16 v57, v140, s92, v7
  v_dot2_f32_bf16 v58, v141, s91, v7
  v_dot2_f32_bf16 v59, v141, s92, v7
  v_dot2_f32_bf16 v60, v142, s91, v7
  v_dot2_f32_bf16 v61, v142, s92, v7
  v_dot2_f32_bf16 v62, v143, s91, v7
  v_dot2_f32_bf16 v63, v143, s92, v7
  v_cvt_pk_bf16_f32 v128, v32, v33
  v_cvt_pk_bf16_f32 v129, v34, v35
  v_cvt_pk_bf16_f32 v130, v36, v37
  v_cvt_pk_bf16_f32 v131, v38, v39
  v_cvt_pk_bf16_f32 v132, v40, v41
  v_cvt_pk_bf16_f32 v133, v42, v43
  v_cvt_pk_bf16_f32 v134, v44, v45
  v_cvt_pk_bf16_f32 v135, v46, v47
  v_cvt_pk_bf16_f32 v136, v48, v49
  v_cvt_pk_bf16_f32 v137, v50, v51
  v_cvt_pk_bf16_f32 v138, v52, v53
  v_cvt_pk_bf16_f32 v139, v54, v55
  v_cvt_pk_bf16_f32 v140, v56, v57
  v_cvt_pk_bf16_f32 v141, v58, v59
  v_cvt_pk_bf16_f32 v142, v60, v61
  v_cvt_pk_bf16_f32 v143, v62, v63
  v_dot2_f32_bf16 v32, v144, s91, v7
  v_dot2_f32_bf16 v33, v144, s92, v7
  v_dot2_f32_bf16 v34, v145, s91, v7
  v_dot2_f32_bf16 v35, v145, s92, v7
  v_dot2_f32_bf16 v36, v146, s91, v7
  v_dot2_f32_bf16 v37, v146, s92, v7
  v_dot2_f32_bf16 v38, v147, s91, v7
  v_dot2_f32_bf16 v39, v147, s92, v7
  v_dot2_f32_bf16 v40, v148, s91, v7
  v_dot2_f32_bf16 v41, v148, s92, v7
  v_dot2_f32_bf16 v42, v149, s91, v7
  v_dot2_f32_bf16 v43, v149, s92, v7
  v_dot2_f32_bf16 v44, v150, s91, v7
  v_dot2_f32_bf16 v45, v150, s92, v7
  v_dot2_f32_bf16 v46, v151, s91, v7
  v_dot2_f32_bf16 v47, v151, s92, v7
  v_dot2_f32_bf16 v48, v152, s91, v7
  v_dot2_f32_bf16 v49, v152, s92, v7
  v_dot2_f32_bf16 v50, v153, s91, v7
  v_dot2_f32_bf16 v51, v153, s92, v7
  v_dot2_f32_bf16 v52, v154, s91, v7
  v_dot2_f32_bf16 v53, v154, s92, v7
  v_dot2_f32_bf16 v54, v155, s91, v7
  v_dot2_f32_bf16 v55, v155, s92, v7
  v_dot2_f32_bf16 v56, v156, s91, v7
  v_dot2_f32_bf16 v57, v156, s92, v7
  v_dot2_f32_bf16 v58, v157, s91, v7
  v_dot2_f32_bf16 v59, v157, s92, v7
  v_dot2_f32_bf16 v60, v158, s91, v7
  v_dot2_f32_bf16 v61, v158, s92, v7
  v_dot2_f32_bf16 v62, v159, s91, v7
  v_dot2_f32_bf16 v63, v159, s92, v7
  s_waitcnt lgkmcnt(0)
  v_cmp_gt_u32 vcc, 2, v73
  s_cbranch_vccnz L_slow_chk1
L_back_chk1:
  ds_read_b128 v[8:11], v2 offset:0
  ds_read_b128 v[12:15], v2 offset:4096
  ds_read_b128 v[16:19], v3 offset:0
  ds_read_b128 v[20:23], v3 offset:4096
  s_waitcnt lgkmcnt(2)
  v_mfma_f32_32x32x16_bf16 v[96:111], v[128:131], v[8:11], 0
  ds_read_b128 v[24:27], v4 offset:0
  v_cvt_pk_bf16_f32 v144, v32, v33
  v_cvt_pk_bf16_f32 v145, v34, v35
  v_cvt_pk_bf16_f32 v146, v36, v37
  v_add_f32 v68, v68, v69
  v_mul_f32 v68, 0x3b000000, v68
  v_mfma_f32_32x32x16_bf16 v[112:127], v[128:131], v[12:15], 0
  ds_read_b128 v[28:31], v4 offset:4096
  v_cvt_pk_bf16_f32 v147, v38, v39
  v_cvt_pk_bf16_f32 v148, v40, v41
  v_fma_f32 v68, -v64, v64, v68
  v_max_f32 v68, 0, v68
  s_waitcnt lgkmcnt(2)
  v_mfma_f32_32x32x16_bf16 v[96:111], v[132:135], v[16:19], v[96:111]
  ds_read_b128 v[8:11], v5 offset:0
  v_cvt_pk_bf16_f32 v149, v42, v43
  v_cvt_pk_bf16_f32 v150, v44, v45
  v_cvt_pk_bf16_f32 v151, v46, v47
  v_cvt_pk_bf16_f32 v68, v68, v68
  v_and_b32 v68, 0xffff0000, v68
  v_mfma_f32_32x32x16_bf16 v[112:127], v[132:135], v[20:23], v[112:127]
  ds_read_b128 v[12:15], v5 offset:4096
  v_cvt_pk_bf16_f32 v152, v48, v49
  v_cvt_pk_bf16_f32 v153, v50, v51
  v_cvt_pk_bf16_f32 v154, v52, v53
  v_add_f32 v68, 0x3727c5ac, v68
  s_waitcnt lgkmcnt(2)
  v_mfma_f32_32x32x16_bf16 v[96:111], v[136:139], v[24:27], v[96:111]
  ds_read_b128 v[16:19], v2 offset:8192
  v_cvt_pk_bf16_f32 v155, v54, v55
  v_cvt_pk_bf16_f32 v156, v56, v57
  v_cvt_pk_bf16_f32 v68, v68, v68
  v_and_b32 v68, 0xffff0000, v68
  v_sqrt_f32 v68, v68
  v_mfma_f32_32x32x16_bf16 v[112:127], v[136:139], v[28:31], v[112:127]
  ds_read_b128 v[20:23], v2 offset:12288
  v_cvt_pk_bf16_f32 v157, v58, v59
  v_cvt_pk_bf16_f32 v158, v60, v61
  v_cvt_pk_bf16_f32 v159, v62, v63
  ds_write_b32 v94, v65 offset:512
  s_waitcnt lgkmcnt(3)
  v_mfma_f32_32x32x16_bf16 v[96:111], v[140:143], v[8:11], v[96:111]
  ds_read_b128 v[24:27], v3 offset:8192
  v_cvt_pk_bf16_f32 v68, v68, v68
  v_and_b32 v68, 0xffff0000, v68
  v_rcp_f32 v68, v68
  ds_write_b32 v94, v68
  v_mul_f32 v0, v68, v68
  v_mfma_f32_32x32x16_bf16 v[112:127], v[140:143], v[12:15], v[112:127]
  ds_read_b128 v[28:31], v3 offset:12288
  v_dot2_f32_bf16 v32, v160, s91, v7
  v_dot2_f32_bf16 v33, v160, s92, v7
  v_dot2_f32_bf16 v34, v161, s91, v7
  v_dot2_f32_bf16 v35, v161, s92, v7
  v_dot2_f32_bf16 v36, v162, s91, v7
  v_dot2_f32_bf16 v37, v162, s92, v7
  v_dot2_f32_bf16 v38, v163, s91, v7
  v_dot2_f32_bf16 v39, v163, s92, v7
  v_dot2_f32_bf16 v40, v164, s91, v7
  v_dot2_f32_bf16 v41, v164, s92, v7
  v_dot2_f32_bf16 v42, v165, s91, v7
  v_dot2_f32_bf16 v43, v165, s92, v7
  v_dot2_f32_bf16 v44, v166, s91, v7
  v_dot2_f32_bf16 v45, v166, s92, v7
  v_dot2_f32_bf16 v46, v167, s91, v7
  v_dot2_f32_bf16 v47, v167, s92, v7
  v_dot2_f32_bf16 v48, v168, s91, v7
  v_dot2_f32_bf16 v49, v168, s92, v7
  v_dot2_f32_bf16 v50, v169, s91, v7
  v_dot2_f32_bf16 v51, v169, s92, v7
  v_dot2_f32_bf16 v52, v170, s91, v7
  v_dot2_f32_bf16 v53, v170, s92, v7
  v_dot2_f32_bf16 v54, v171, s91, v7
  v_dot2_f32_bf16 v55, v171, s92, v7
  v_dot2_f32_bf16 v56, v172, s91, v7
  v_dot2_f32_bf16 v57, v172, s92, v7
  v_dot2_f32_bf16 v58, v173, s91, v7
  v_dot2_f32_bf16 v59, v173, s92, v7
  v_dot2_f32_bf16 v60, v174, s91, v7
  v_dot2_f32_bf16 v61, v174, s92, v7
  v_dot2_f32_bf16 v62, v175, s91, v7
  v_dot2_f32_bf16 v63, v175, s92, v7
  s_waitcnt lgkmcnt(4)
  v_mfma_f32_32x32x16_bf16 v[96:111], v[144:147], v[16:19], v[96:111]
  ds_read_b128 v[8:11], v4 offset:8192
  v_cvt_pk_bf16_f32 v160, v32, v33
  v_cvt_pk_bf16_f32 v161, v34, v35
  v_cvt_pk_bf16_f32 v162, v36, v37
  v_mfma_f32_32x32x16_bf16 v[112:127], v[144:147], v[20:23], v[112:127]
  ds_read_b128 v[12:15], v4 offset:12288
  v_cvt_pk_bf16_f32 v163, v38, v39
  v_cvt_pk_bf16_f32 v164, v40, v41
  s_waitcnt lgkmcnt(2)
  v_mfma_f32_32x32x16_bf16 v[96:111], v[148:151], v[24:27], v[96:111]
  ds_read_b128 v[16:19], v5 offset:8192
  v_cvt_pk_bf16_f32 v165, v42, v43
  v_cvt_pk_bf16_f32 v166, v44, v45
  v_cvt_pk_bf16_f32 v167, v46, v47
  v_mfma_f32_32x32x16_bf16 v[112:127], v[148:151], v[28:31], v[112:127]
  ds_read_b128 v[20:23], v5 offset:12288
  v_cvt_pk_bf16_f32 v168, v48, v49
  v_cvt_pk_bf16_f32 v169, v50, v51
  v_cvt_pk_bf16_f32 v170, v52, v53
  s_waitcnt lgkmcnt(2)
  v_mfma_f32_32x32x16_bf16 v[96:111], v[152:155], v[8:11], v[96:111]
  ds_read_b128 v[24:27], v2 offset:16384
  v_cvt_pk_bf16_f32 v171, v54, v55
  v_cvt_pk_bf16_f32 v172, v56, v57
  v_mfma_f32_32x32x16_bf16 v[112:127], v[152:155], v[12:15], v[112:127]
  ds_read_b128 v[28:31], v2 offset:20480
  v_cvt_pk_bf16_f32 v173, v58, v59
  v_cvt_pk_bf16_f32 v174, v60, v61
  v_cvt_pk_bf16_f32 v175, v62, v63
  s_waitcnt lgkmcnt(2)
  v_mfma_f32_32x32x16_bf16 v[96:111], v[156:159], v[16:19], v[96:111]
  ds_read_b128 v[8:11], v3 offset:16384
  v_mfma_f32_32x32x16_bf16 v[112:127], v[156:159], v[20:23], v[112:127]
  ds_read_b128 v[12:15], v3 offset:20480
  v_dot2_f32_bf16 v32, v176, s91, v7
  v_dot2_f32_bf16 v33, v176, s92, v7
  v_dot2_f32_bf16 v34, v177, s91, v7
  v_dot2_f32_bf16 v35, v177, s92, v7
  v_dot2_f32_bf16 v36, v178, s91, v7
  v_dot2_f32_bf16 v37, v178, s92, v7
  v_dot2_f32_bf16 v38, v179, s91, v7
  v_dot2_f32_bf16 v39, v179, s92, v7
  v_dot2_f32_bf16 v40, v180, s91, v7
  v_dot2_f32_bf16 v41, v180, s92, v7
  v_dot2_f32_bf16 v42, v181, s91, v7
  v_dot2_f32_bf16 v43, v181, s92, v7
  v_dot2_f32_bf16 v44, v182, s91, v7
  v_dot2_f32_bf16 v45, v182, s92, v7
  v_dot2_f32_bf16 v46, v183, s91, v7
  v_dot2_f32_bf16 v47, v183, s92, v7
  v_dot2_f32_bf16 v48, v184, s91, v7
  v_dot2_f32_bf16 v49, v184, s92, v7
  v_dot2_f32_bf16 v50, v185, s91, v7
  v_dot2_f32_bf16 v51, v185, s92, v7
  v_dot2_f32_bf16 v52, v186, s91, v7
  v_dot2_f32_bf16 v53, v186, s92, v7
  v_dot2_f32_bf16 v54, v187, s91, v7
  v_dot2_f32_bf16 v55, v187, s92, v7
  v_dot2_f32_bf16 v56, v188, s91, v7
  v_dot2_f32_bf16 v57, v188, s92, v7
  v_dot2_f32_bf16 v58, v189, s91, v7
  v_dot2_f32_bf16 v59, v189, s92, v7
  v_dot2_f32_bf16 v60, v190, s91, v7
  v_dot2_f32_bf16 v61, v190, s92, v7
  v_dot2_f32_bf16 v62, v191, s91, v7
  v_dot2_f32_bf16 v63, v191, s92, v7
  s_waitcnt lgkmcnt(2)
  v_mfma_f32_32x32x16_bf16 v[96:111], v[160:163], v[24:27], v[96:111]
  ds_read_b128 v[16:19], v4 offset:16384
  v_cvt_pk_bf16_f32 v176, v32, v33
  v_cvt_pk_bf16_f32 v177, v34, v35
  v_cvt_pk_bf16_f32 v178, v36, v37
  v_mfma_f32_32x32x16_bf16 v[112:127], v[160:163], v[28:31], v[112:127]
  ds_read_b128 v[20:23], v4 offset:20480
  v_cvt_pk_bf16_f32 v179, v38, v39
  v_cvt_pk_bf16_f32 v180, v40, v41
  s_waitcnt lgkmcnt(2)
  v_mfma_f32_32x32x16_bf16 v[96:111], v[164:167], v[8:11], v[96:111]
  ds_read_b128 v[24:27], v5 offset:16384
  v_cvt_pk_bf16_f32 v181, v42, v43
  v_cvt_pk_bf16_f32 v182, v44, v45
  v_cvt_pk_bf16_f32 v183, v46, v47
  v_mfma_f32_32x32x16_bf16 v[112:127], v[164:167], v[12:15], v[112:127]
  ds_read_b128 v[28:31], v5 offset:20480
  v_cvt_pk_bf16_f32 v184, v48, v49
  v_cvt_pk_bf16_f32 v185, v50, v51
  v_cvt_pk_bf16_f32 v186, v52, v53
  s_waitcnt lgkmcnt(2)
  v_mfma_f32_32x32x16_bf16 v[96:111], v[168:171], v[16:19], v[96:111]
  ds_read_b128 v[8:11], v2 offset:24576
  v_cvt_pk_bf16_f32 v187, v54, v55
  v_cvt_pk_bf16_f32 v188, v56, v57
  v_mfma_f32_32x32x16_bf16 v[112:127], v[168:171], v[20:23], v[112:127]
  ds_read_b128 v[12:15], v2 offset:28672
  v_cvt_pk_bf16_f32 v189, v58, v59
  v_cvt_pk_bf16_f32 v190, v60, v61
  v_cvt_pk_bf16_f32 v191, v62, v63
  s_waitcnt lgkmcnt(2)
  v_mfma_f32_32x32x16_bf16 v[96:111], v[172:175], v[24:27], v[96:111]
  ds_read_b32 v73, v72 offset:16
  ds_read_b128 v[16:19], v3 offset:24576
  v_mfma_f32_32x32x16_bf16 v[112:127], v[172:175], v[28:31], v[112:127]
  ds_read_b128 v[20:23], v3 offset:28672
  v_dot2_f32_bf16 v32, v192, s91, v7
  v_dot2_f32_bf16 v33, v192, s92, v7
  v_dot2_f32_bf16 v34, v193, s91, v7
  v_dot2_f32_bf16 v35, v193, s92, v7
  v_dot2_f32_bf16 v36, v194, s91, v7
  v_dot2_f32_bf16 v37, v194, s92, v7
  v_dot2_f32_bf16 v38, v195, s91, v7
  v_dot2_f32_bf16 v39, v195, s92, v7
  v_dot2_f32_bf16 v40, v196, s91, v7
  v_dot2_f32_bf16 v41, v196, s92, v7
  v_dot2_f32_bf16 v42, v197, s91, v7
  v_dot2_f32_bf16 v43, v197, s92, v7
  v_dot2_f32_bf16 v44, v198, s91, v7
  v_dot2_f32_bf16 v45, v198, s92, v7
  v_dot2_f32_bf16 v46, v199, s91, v7
  v_dot2_f32_bf16 v47, v199, s92, v7
  v_dot2_f32_bf16 v48, v200, s91, v7
  v_dot2_f32_bf16 v49, v200, s92, v7
  v_dot2_f32_bf16 v50, v201, s91, v7
  v_dot2_f32_bf16 v51, v201, s92, v7
  v_dot2_f32_bf16 v52, v202, s91, v7
  v_dot2_f32_bf16 v53, v202, s92, v7
  v_dot2_f32_bf16 v54, v203, s91, v7
  v_dot2_f32_bf16 v55, v203, s92, v7
  v_dot2_f32_bf16 v56, v204, s91, v7
  v_dot2_f32_bf16 v57, v204, s92, v7
  v_dot2_f32_bf16 v58, v205, s91, v7
  v_dot2_f32_bf16 v59, v205, s92, v7
  v_dot2_f32_bf16 v60, v206, s91, v7
  v_dot2_f32_bf16 v61, v206, s92, v7
  v_dot2_f32_bf16 v62, v207, s91, v7
  v_dot2_f32_bf16 v63, v207, s92, v7
  s_waitcnt lgkmcnt(3)
  v_mfma_f32_32x32x16_bf16 v[96:111], v[176:179], v[8:11], v[96:111]
  ds_read_b128 v[24:27], v4 offset:24576
  v_cvt_pk_bf16_f32 v192, v32, v33
  v_cvt_pk_bf16_f32 v193, v34, v35
  v_cvt_pk_bf16_f32 v194, v36, v37
  v_mfma_f32_32x32x16_bf16 v[112:127], v[176:179], v[12:15], v[112:127]
  ds_read_b128 v[28:31], v4 offset:28672
  v_cvt_pk_bf16_f32 v195, v38, v39
  v_cvt_pk_bf16_f32 v196, v40, v41
  s_waitcnt lgkmcnt(2)
  v_mfma_f32_32x32x16_bf16 v[96:111], v[180:183], v[16:19], v[96:111]
  ds_read_b128 v[8:11], v5 offset:24576
  v_cvt_pk_bf16_f32 v197, v42, v43
  v_cvt_pk_bf16_f32 v198, v44, v45
  v_cvt_pk_bf16_f32 v199, v46, v47
  v_mfma_f32_32x32x16_bf16 v[112:127], v[180:183], v[20:23], v[112:127]
  ds_read_b128 v[12:15], v5 offset:28672
  v_cvt_pk_bf16_f32 v200, v48, v49
  v_cvt_pk_bf16_f32 v201, v50, v51
  v_cvt_pk_bf16_f32 v202, v52, v53
  s_waitcnt lgkmcnt(2)
  v_mfma_f32_32x32x16_bf16 v[96:111], v[184:187], v[24:27], v[96:111]
  v_cmp_gt_u32 vcc, 4, v73
  s_cbranch_vccnz L_slow_chk2
L_back_chk2:
  ds_read_b128 v[16:19], v2 offset:32768
  v_cvt_pk_bf16_f32 v203, v54, v55
  v_cvt_pk_bf16_f32 v204, v56, v57
  v_mfma_f32_32x32x16_bf16 v[112:127], v[184:187], v[28:31], v[112:127]
  ds_read_b128 v[20:23], v2 offset:36864
  v_cvt_pk_bf16_f32 v205, v58, v59
  v_cvt_pk_bf16_f32 v206, v60, v61
  v_cvt_pk_bf16_f32 v207, v62, v63
  s_waitcnt lgkmcnt(2)
  v_mfma_f32_32x32x16_bf16 v[96:111], v[188:191], v[8:11], v[96:111]
  ds_read_b128 v[24:27], v3 offset:32768
  v_mfma_f32_32x32x16_bf16 v[112:127], v[188:191], v[12:15], v[112:127]
  v_mov_b32 v74, 3
  ds_write_b32 v75, v74 offset:0
  ds_read_b128 v[28:31], v3 offset:36864
  v_dot2_f32_bf16 v32, v208, s91, v7
  v_dot2_f32_bf16 v33, v208, s92, v7
  v_dot2_f32_bf16 v34, v209, s91, v7
  v_dot2_f32_bf16 v35, v209, s92, v7
  v_dot2_f32_bf16 v36, v210, s91, v7
  v_dot2_f32_bf16 v37, v210, s92, v7
  v_dot2_f32_bf16 v38, v211, s91, v7
  v_dot2_f32_bf16 v39, v211, s92, v7
  v_dot2_f32_bf16 v40, v212, s91, v7
  v_dot2_f32_bf16 v41, v212, s92, v7
  v_dot2_f32_bf16 v42, v213, s91, v7
  v_dot2_f32_bf16 v43, v213, s92, v7
  v_dot2_f32_bf16 v44, v214, s91, v7
  v_dot2_f32_bf16 v45, v214, s92, v7
  v_dot2_f32_bf16 v46, v215, s91, v7
  v_dot2_f32_bf16 v47, v215, s92, v7
  v_dot2_f32_bf16 v48, v216, s91, v7
  v_dot2_f32_bf16 v49, v216, s92, v7
  v_dot2_f32_bf16 v50, v217, s91, v7
  v_dot2_f32_bf16 v51, v217, s92, v7
  v_dot2_f32_bf16 v52, v218, s91, v7
  v_dot2_f32_bf16 v53, v218, s92, v7
  v_dot2_f32_bf16 v54, v219, s91, v7
  v_dot2_f32_bf16 v55, v219, s92, v7
  v_dot2_f32_bf16 v56, v220, s91, v7
  v_dot2_f32_bf16 v57, v220, s92, v7
  v_dot2_f32_bf16 v58, v221, s91, v7
  v_dot2_f32_bf16 v59, v221, s92, v7
  v_dot2_f32_bf16 v60, v222, s91, v7
  v_dot2_f32_bf16 v61, v222, s92, v7
  v_dot2_f32_bf16 v62, v223, s91, v7
  v_dot2_f32_bf16 v63, v223, s92, v7
  s_waitcnt lgkmcnt(3)
  v_mfma_f32_32x32x16_bf16 v[96:111], v[192:195], v[16:19], v[96:111]
  ds_read_b128 v[8:11], v4 offset:32768
  v_cvt_pk_bf16_f32 v208, v32, v33
  v_cvt_pk_bf16_f32 v209, v34, v35
  v_cvt_pk_bf16_f32 v210, v36, v37
  v_mfma_f32_32x32x16_bf16 v[112:127], v[192:195], v[20:23], v[112:127]
  ds_read_b128 v[12:15], v4 offset:36864
  v_cvt_pk_bf16_f32 v211, v38, v39
  v_cvt_pk_bf16_f32 v212, v40, v41
  s_waitcnt lgkmcnt(2)
  v_mfma_f32_32x32x16_bf16 v[96:111], v[196:199], v[24:27], v[96:111]
  ds_read_b128 v[16:19], v5 offset:32768
  v_cvt_pk_bf16_f32 v213, v42, v43
  v_cvt_pk_bf16_f32 v214, v44, v45
  v_cvt_pk_bf16_f32 v215, v46, v47
  v_mfma_f32_32x32x16_bf16 v[112:127], v[196:199], v[28:31], v[112:127]
  ds_read_b128 v[20:23], v5 offset:36864
  v_cvt_pk_bf16_f32 v216, v48, v49
  v_cvt_pk_bf16_f32 v217, v50, v51
  v_cvt_pk_bf16_f32 v218, v52, v53
  s_waitcnt lgkmcnt(2)
  v_mfma_f32_32x32x16_bf16 v[96:111], v[200:203], v[8:11], v[96:111]
  ds_read_b128 v[24:27], v2 offset:40960
  v_cvt_pk_bf16_f32 v219, v54, v55
  v_cvt_pk_bf16_f32 v220, v56, v57
  v_mfma_f32_32x32x16_bf16 v[112:127], v[200:203], v[12:15], v[112:127]
  ds_read_b128 v[28:31], v2 offset:45056
  v_cvt_pk_bf16_f32 v221, v58, v59
  v_cvt_pk_bf16_f32 v222, v60, v61
  v_cvt_pk_bf16_f32 v223, v62, v63
  s_waitcnt lgkmcnt(2)
  v_mfma_f32_32x32x16_bf16 v[96:111], v[204:207], v[16:19], v[96:111]
  ds_read_b128 v[8:11], v3 offset:40960
  v_mfma_f32_32x32x16_bf16 v[112:127], v[204:207], v[20:23], v[112:127]
  ds_read_b128 v[12:15], v3 offset:45056
  v_dot2_f32_bf16 v32, v224, s91, v7
  v_dot2_f32_bf16 v33, v224, s92, v7
  v_dot2_f32_bf16 v34, v225, s91, v7
  v_dot2_f32_bf16 v35, v225, s92, v7
  v_dot2_f32_bf16 v36, v226, s91, v7
  v_dot2_f32_bf16 v37, v226, s92, v7
  v_dot2_f32_bf16 v38, v227, s91, v7
  v_dot2_f32_bf16 v39, v227, s92, v7
  v_dot2_f32_bf16 v40, v228, s91, v7
  v_dot2_f32_bf16 v41, v228, s92, v7
  v_dot2_f32_bf16 v42, v229, s91, v7
  v_dot2_f32_bf16 v43, v229, s92, v7
  v_dot2_f32_bf16 v44, v230, s91, v7
  v_dot2_f32_bf16 v45, v230, s92, v7
  v_dot2_f32_bf16 v46, v231, s91, v7
  v_dot2_f32_bf16 v47, v231, s92, v7
  v_dot2_f32_bf16 v48, v232, s91, v7
  v_dot2_f32_bf16 v49, v232, s92, v7
  v_dot2_f32_bf16 v50, v233, s91, v7
  v_dot2_f32_bf16 v51, v233, s92, v7
  v_dot2_f32_bf16 v52, v234, s91, v7
  v_dot2_f32_bf16 v53, v234, s92, v7
  v_dot2_f32_bf16 v54, v235, s91, v7
  v_dot2_f32_bf16 v55, v235, s92, v7
  v_dot2_f32_bf16 v56, v236, s91, v7
  v_dot2_f32_bf16 v57, v236, s92, v7
  v_dot2_f32_bf16 v58, v237, s91, v7
  v_dot2_f32_bf16 v59, v237, s92, v7
  v_dot2_f32_bf16 v60, v238, s91, v7
  v_dot2_f32_bf16 v61, v238, s92, v7
  v_dot2_f32_bf16 v62, v239, s91, v7
  v_dot2_f32_bf16 v63, v239, s92, v7
  s_waitcnt lgkmcnt(2)
  v_mfma_f32_32x32x16_bf16 v[96:111], v[208:211], v[24:27], v[96:111]
  ds_read_b128 v[16:19], v4 offset:40960
  v_cvt_pk_bf16_f32 v224, v32, v33
  v_cvt_pk_bf16_f32 v225, v34, v35
  v_cvt_pk_bf16_f32 v226, v36, v37
  v_mfma_f32_32x32x16_bf16 v[112:127], v[208:211], v[28:31], v[112:127]
  ds_read_b128 v[20:23], v4 offset:45056
  v_cvt_pk_bf16_f32 v227, v38, v39
  v_cvt_pk_bf16_f32 v228, v40, v41
  s_waitcnt lgkmcnt(2)
  v_mfma_f32_32x32x16_bf16 v[96:111], v[212:215], v[8:11], v[96:111]
  ds_read_b128 v[24:27], v5 offset:40960
  v_cvt_pk_bf16_f32 v229, v42, v43
  v_cvt_pk_bf16_f32 v230, v44, v45
  v_cvt_pk_bf16_f32 v231, v46, v47
  v_mfma_f32_32x32x16_bf16 v[112:127], v[212:215], v[12:15], v[112:127]
  ds_read_b128 v[28:31], v5 offset:45056
  v_cvt_pk_bf16_f32 v232, v48, v49
  v_cvt_pk_bf16_f32 v233, v50, v51
  v_cvt_pk_bf16_f32 v234, v52, v53
  s_waitcnt lgkmcnt(2)
  v_mfma_f32_32x32x16_bf16 v[96:111], v[216:219], v[16:19], v[96:111]
  ds_read_b128 v[8:11], v2 offset:49152
  v_cvt_pk_bf16_f32 v235, v54, v55
  v_cvt_pk_bf16_f32 v236, v56, v57
  v_mfma_f32_32x32x16_bf16 v[112:127], v[216:219], v[20:23], v[112:127]
  ds_read_b128 v[12:15], v2 offset:53248
  v_cvt_pk_bf16_f32 v237, v58, v59
  v_cvt_pk_bf16_f32 v238, v60, v61
  v_cvt_pk_bf16_f32 v239, v62, v63
  s_waitcnt lgkmcnt(2)
  v_mfma_f32_32x32x16_bf16 v[96:111], v[220:223], v[24:27], v[96:111]
  ds_read_b128 v[16:19], v3 offset:49152
  v_mfma_f32_32x32x16_bf16 v[112:127], v[220:223], v[28:31], v[112:127]
  v_mov_b32 v74, 4
  ds_write_b32 v75, v74 offset:0
  ds_read_b128 v[20:23], v3 offset:53248
  v_dot2_f32_bf16 v32, v240, s91, v7
  v_dot2_f32_bf16 v33, v240, s92, v7
  v_dot2_f32_bf16 v34, v241, s91, v7
  v_dot2_f32_bf16 v35, v241, s92, v7
  v_dot2_f32_bf16 v36, v242, s91, v7
  v_dot2_f32_bf16 v37, v242, s92, v7
  v_dot2_f32_bf16 v38, v243, s91, v7
  v_dot2_f32_bf16 v39, v243, s92, v7
  v_dot2_f32_bf16 v40, v244, s91, v7
  v_dot2_f32_bf16 v41, v244, s92, v7
  v_dot2_f32_bf16 v42, v245, s91, v7
  v_dot2_f32_bf16 v43, v245, s92, v7
  v_dot2_f32_bf16 v44, v246, s91, v7
  v_dot2_f32_bf16 v45, v246, s92, v7
  v_dot2_f32_bf16 v46, v247, s91, v7
  v_dot2_f32_bf16 v47, v247, s92, v7
  v_dot2_f32_bf16 v48, v248, s91, v7
  v_dot2_f32_bf16 v49, v248, s92, v7
  v_dot2_f32_bf16 v50, v249, s91, v7
  v_dot2_f32_bf16 v51, v249, s92, v7
  v_dot2_f32_bf16 v52, v250, s91, v7
  v_dot2_f32_bf16 v53, v250, s92, v7
  v_dot2_f32_bf16 v54, v251, s91, v7
  v_dot2_f32_bf16 v55, v251, s92, v7
  v_dot2_f32_bf16 v56, v252, s91, v7
  v_dot2_f32_bf16 v57, v252, s92, v7
  v_dot2_f32_bf16 v58, v253, s91, v7
  v_dot2_f32_bf16 v59, v253, s92, v7
  v_dot2_f32_bf16 v60, v254, s91, v7
  v_dot2_f32_bf16 v61, v254, s92, v7
  v_dot2_f32_bf16 v62, v255, s91, v7
  v_dot2_f32_bf16 v63, v255, s92, v7
  s_waitcnt lgkmcnt(3)
  v_mfma_f32_32x32x16_bf16 v[96:111], v[224:227], v[8:11], v[96:111]
  ds_read_b128 v[24:27], v4 offset:49152
  v_cvt_pk_bf16_f32 v240, v32, v33
  v_cvt_pk_bf16_f32 v241, v34, v35
  v_cvt_pk_bf16_f32 v242, v36, v37
  v_mfma_f32_32x32x16_bf16 v[112:127], v[224:227], v[12:15], v[112:127]
  ds_read_b128 v[28:31], v4 offset:53248
  v_cvt_pk_bf16_f32 v243, v38, v39
  v_cvt_pk_bf16_f32 v244, v40, v41
  s_waitcnt lgkmcnt(2)
  v_mfma_f32_32x32x16_bf16 v[96:111], v[228:231], v[16:19], v[96:111]
  ds_read_b128 v[8:11], v5 offset:49152
  v_cvt_pk_bf16_f32 v245, v42, v43
  v_cvt_pk_bf16_f32 v246, v44, v45
  v_cvt_pk_bf16_f32 v247, v46, v47
  v_mfma_f32_32x32x16_bf16 v[112:127], v[228:231], v[20:23], v[112:127]
  ds_read_b128 v[12:15], v5 offset:53248
  v_cvt_pk_bf16_f32 v248, v48, v49
  v_cvt_pk_bf16_f32 v249, v50, v51
  v_cvt_pk_bf16_f32 v250, v52, v53
  s_waitcnt lgkmcnt(2)
  v_mfma_f32_32x32x16_bf16 v[96:111], v[232:235], v[24:27], v[96:111]
  ds_read_b128 v[16:19], v2 offset:57344
  v_cvt_pk_bf16_f32 v251, v54, v55
  v_cvt_pk_bf16_f32 v252, v56, v57
  v_lshlrev_b32 v7, 6, v1
  v_bfe_u32 v64, v1, 1, 2
  v_lshl_add_u32 v7, v64, 4, v7
  v_mfma_f32_32x32x16_bf16 v[112:127], v[232:235], v[28:31], v[112:127]
  ds_read_b128 v[20:23], v2 offset:61440
  v_cvt_pk_bf16_f32 v253, v58, v59
  v_cvt_pk_bf16_f32 v254, v60, v61
  v_cvt_pk_bf16_f32 v255, v62, v63
  v_add_u32 v7, s88, v7
  s_waitcnt lgkmcnt(2)
  v_mfma_f32_32x32x16_bf16 v[96:111], v[236:239], v[8:11], v[96:111]
  ds_read_b32 v73, v72 offset:16
  ds_read_b128 v[24:27], v3 offset:57344
  v_add_u32 v7, 98304, v7
  v_mfma_f32_32x32x16_bf16 v[112:127], v[236:239], v[12:15], v[112:127]
  ds_read_b128 v[28:31], v3 offset:61440
  s_waitcnt lgkmcnt(3)
  v_mfma_f32_32x32x16_bf16 v[96:111], v[240:243], v[16:19], v[96:111]
  ds_read_b128 v[8:11], v4 offset:57344
  v_mfma_f32_32x32x16_bf16 v[112:127], v[240:243], v[20:23], v[112:127]
  ds_read_b128 v[12:15], v4 offset:61440
  s_waitcnt lgkmcnt(2)
  v_mfma_f32_32x32x16_bf16 v[96:111], v[244:247], v[24:27], v[96:111]
  ds_read_b128 v[16:19], v5 offset:57344
  v_mfma_f32_32x32x16_bf16 v[112:127], v[244:247], v[28:31], v[112:127]
  ds_read_b128 v[20:23], v5 offset:61440
  s_waitcnt lgkmcnt(2)
  v_mfma_f32_32x32x16_bf16 v[96:111], v[248:251], v[8:11], v[96:111]
  v_cmp_gt_u32 vcc, 5, v73
  s_cbranch_vccnz L_slow_chk3
L_back_chk3:
  ds_read_b64_tr_b16 v[24:25], v6 offset:0
  ds_read_b64_tr_b16 v[26:27], v6 offset:768
  v_mfma_f32_32x32x16_bf16 v[112:127], v[248:251], v[12:15], v[112:127]
  ds_read_b64_tr_b16 v[28:29], v6 offset:12288
  ds_read_b64_tr_b16 v[30:31], v6 offset:13056
  s_waitcnt lgkmcnt(4)
  v_mfma_f32_32x32x16_bf16 v[96:111], v[252:255], v[16:19], v[96:111]
  v_mov_b32 v2, v72
  v_mov_b32 v5, v75
  ds_read_b64_tr_b16 v[8:9], v6 offset:64
  ds_read_b64_tr_b16 v[10:11], v6 offset:832
  v_mfma_f32_32x32x16_bf16 v[112:127], v[252:255], v[20:23], v[112:127]
  ds_read_b32 v3, v2 offset:0
  ds_read_b64_tr_b16 v[12:13], v6 offset:12352
  ds_read_b64_tr_b16 v[14:15], v6 offset:13120
  s_waitcnt lgkmcnt(5)
  v_mfma_f32_32x32x16_bf16 v[32:47], v[24:27], v[128:131], 0
  ds_read_b64_tr_b16 v[16:17], v6 offset:3072
  ds_read_b64_tr_b16 v[18:19], v6 offset:3840
  v_mfma_f32_32x32x16_bf16 v[48:63], v[28:31], v[128:131], 0
  ds_write_b128 v7, v[96:99] offset:32768
  ds_read_b64_tr_b16 v[20:21], v6 offset:15360
  ds_read_b64_tr_b16 v[22:23], v6 offset:16128
  s_waitcnt lgkmcnt(5)
  v_mfma_f32_32x32x16_bf16 v[64:79], v[8:11], v[128:131], 0
  v_cmp_gt_u32 vcc, 4, v3
  s_cbranch_vccnz L_slow_chk4
L_back_chk4:
  ds_write_b128 v7, v[112:115] offset:0
  ds_read_b64_tr_b16 v[24:25], v6 offset:3136
  ds_read_b64_tr_b16 v[26:27], v6 offset:3904
  v_mfma_f32_32x32x16_bf16 v[80:95], v[12:15], v[128:131], 0
  ds_read_b64_tr_b16 v[28:29], v6 offset:15424
  ds_read_b64_tr_b16 v[30:31], v6 offset:16192
  s_waitcnt lgkmcnt(5)
  v_mfma_f32_32x32x16_bf16 v[32:47], v[16:19], v[132:135], v[32:47]
  v_xor_b32 v7, 16, v7
  ds_write_b128 v7, v[100:103] offset:32768
  ds_read_b64_tr_b16 v[8:9], v6 offset:6144
  ds_read_b64_tr_b16 v[10:11], v6 offset:6912
  v_mfma_f32_32x32x16_bf16 v[48:63], v[20:23], v[132:135], v[48:63]
  ds_write_b128 v7, v[116:119] offset:0
  ds_read_b64_tr_b16 v[12:13], v6 offset:18432
  ds_read_b64_tr_b16 v[14:15], v6 offset:19200
  s_waitcnt lgkmcnt(6)
  v_mfma_f32_32x32x16_bf16 v[64:79], v[24:27], v[132:135], v[64:79]
  ds_read_b64_tr_b16 v[16:17], v6 offset:6208
  ds_read_b64_tr_b16 v[18:19], v6 offset:6976
  v_mfma_f32_32x32x16_bf16 v[80:95], v[28:31], v[132:135], v[80:95]
  v_xor_b32 v7, 48, v7
  ds_write_b128 v7, v[104:107] offset:32768
  ds_read_b64_tr_b16 v[20:21], v6 offset:18496
  ds_read_b64_tr_b16 v[22:23], v6 offset:19264
  s_waitcnt lgkmcnt(5)
  v_mfma_f32_32x32x16_bf16 v[32:47], v[8:11], v[136:139], v[32:47]
  ds_write_b128 v7, v[120:123] offset:0
  ds_read_b64_tr_b16 v[24:25], v6 offset:9216
  ds_read_b64_tr_b16 v[26:27], v6 offset:9984
  v_mfma_f32_32x32x16_bf16 v[48:63], v[12:15], v[136:139], v[48:63]
  ds_read_b64_tr_b16 v[28:29], v6 offset:21504
  ds_read_b64_tr_b16 v[30:31], v6 offset:22272
  s_waitcnt lgkmcnt(5)
  v_mfma_f32_32x32x16_bf16 v[64:79], v[16:19], v[136:139], v[64:79]
  v_xor_b32 v7, 16, v7
  ds_write_b128 v7, v[108:111] offset:32768
  ds_read_b64_tr_b16 v[8:9], v6 offset:9280
  ds_read_b64_tr_b16 v[10:11], v6 offset:10048
  v_mfma_f32_32x32x16_bf16 v[80:95], v[20:23], v[136:139], v[80:95]
  ds_write_b128 v7, v[124:127] offset:0
  ds_read_b64_tr_b16 v[12:13], v6 offset:21568
  ds_read_b64_tr_b16 v[14:15], v6 offset:22336
  s_waitcnt lgkmcnt(6)
  v_mfma_f32_32x32x16_bf16 v[32:47], v[24:27], v[140:143], v[32:47]
  ds_read_b64_tr_b16 v[16:17], v6 offset:128
  ds_read_b64_tr_b16 v[18:19], v6 offset:896
  v_mfma_f32_32x32x16_bf16 v[48:63], v[28:31], v[140:143], v[48:63]
  ds_read_b64_tr_b16 v[20:21], v6 offset:12416
  ds_read_b64_tr_b16 v[22:23], v6 offset:13184
  s_waitcnt lgkmcnt(4)
  v_mfma_f32_32x32x16_bf16 v[64:79], v[8:11], v[140:143], v[64:79]
  ds_read_b32 v3, v2 offset:16
  ds_read_b64_tr_b16 v[24:25], v6 offset:3200
  ds_read_b64_tr_b16 v[26:27], v6 offset:3968
  v_mfma_f32_32x32x16_bf16 v[80:95], v[12:15], v[140:143], v[80:95]
  v_mov_b32 v4, 5
  ds_write_b32 v5, v4 offset:0
  ds_read_b64_tr_b16 v[28:29], v6 offset:15488
  ds_read_b64_tr_b16 v[30:31], v6 offset:16256
  s_waitcnt lgkmcnt(6)
  v_mfma_f32_32x32x16_bf16 v[96:111], v[16:19], v[128:131], 0
  ds_read_b64_tr_b16 v[8:9], v6 offset:6272
  ds_read_b64_tr_b16 v[10:11], v6 offset:7040
  v_mfma_f32_32x32x16_bf16 v[112:127], v[20:23], v[128:131], 0
  ds_read_b64_tr_b16 v[12:13], v6 offset:18560
  ds_read_b64_tr_b16 v[14:15], v6 offset:19328
  s_waitcnt lgkmcnt(4)
  v_mfma_f32_32x32x16_bf16 v[96:111], v[24:27], v[132:135], v[96:111]
  ds_read_b64_tr_b16 v[16:17], v6 offset:9344
  ds_read_b64_tr_b16 v[18:19], v6 offset:10112
  v_mfma_f32_32x32x16_bf16 v[112:127], v[28:31], v[132:135], v[112:127]
  ds_read_b64_tr_b16 v[20:21], v6 offset:21632
  ds_read_b64_tr_b16 v[22:23], v6 offset:22400
  s_waitcnt lgkmcnt(4)
  v_mfma_f32_32x32x16_bf16 v[96:111], v[8:11], v[136:139], v[96:111]
  v_cmp_gt_u32 vcc, 6, v3
  s_cbranch_vccnz L_slow_chk5
L_back_chk5:
  ds_read_b64_tr_b16 v[24:25], v6 offset:24576
  ds_read_b64_tr_b16 v[26:27], v6 offset:25344
  v_mfma_f32_32x32x16_bf16 v[112:127], v[12:15], v[136:139], v[112:127]
  ds_read_b64_tr_b16 v[28:29], v6 offset:36864
  ds_read_b64_tr_b16 v[30:31], v6 offset:37632
  s_waitcnt lgkmcnt(4)
  v_mfma_f32_32x32x16_bf16 v[96:111], v[16:19], v[140:143], v[96:111]
  ds_read_b64_tr_b16 v[8:9], v6 offset:24640
  ds_read_b64_tr_b16 v[10:11], v6 offset:25408
  v_mfma_f32_32x32x16_bf16 v[112:127], v[20:23], v[140:143], v[112:127]
  ds_read_b64_tr_b16 v[12:13], v6 offset:36928
  ds_read_b64_tr_b16 v[14:15], v6 offset:37696
  s_waitcnt lgkmcnt(4)
  v_mfma_f32_32x32x16_bf16 v[32:47], v[24:27], v[144:147], v[32:47]
  s_lshl_b32 s9, s3, 11
  s_add_u32 s9, s9, 152576
  v_lshl_add_u32 v136, v1, 4, s9
  ds_read_b128 v[128:131], v136
  ds_read_b64_tr_b16 v[16:17], v6 offset:24704
  ds_read_b64_tr_b16 v[18:19], v6 offset:25472
  v_mfma_f32_32x32x16_bf16 v[48:63], v[28:31], v[144:147], v[48:63]
  v_mov_b32 v4, 6
  ds_write_b32 v5, v4 offset:0
  ds_read_b64_tr_b16 v[20:21], v6 offset:36992
  ds_read_b64_tr_b16 v[22:23], v6 offset:37760
  s_waitcnt lgkmcnt(6)
  v_mfma_f32_32x32x16_bf16 v[64:79], v[8:11], v[144:147], v[64:79]
  ds_read_b64_tr_b16 v[24:25], v6 offset:27648
  ds_read_b64_tr_b16 v[26:27], v6 offset:28416
  v_mfma_f32_32x32x16_bf16 v[80:95], v[12:15], v[144:147], v[80:95]
  ds_read_b64_tr_b16 v[28:29], v6 offset:39936
  ds_read_b64_tr_b16 v[30:31], v6 offset:40704
  s_waitcnt lgkmcnt(4)
  v_mfma_f32_32x32x16_bf16 v[96:111], v[16:19], v[144:147], v[96:111]
  ds_read_b64_tr_b16 v[8:9], v6 offset:27712
  ds_read_b64_tr_b16 v[10:11], v6 offset:28480
  v_mfma_f32_32x32x16_bf16 v[112:127], v[20:23], v[144:147], v[112:127]
  ds_read_b64_tr_b16 v[12:13], v6 offset:40000
  ds_read_b64_tr_b16 v[14:15], v6 offset:40768
  s_waitcnt lgkmcnt(4)
  v_mfma_f32_32x32x16_bf16 v[32:47], v[24:27], v[148:151], v[32:47]
  ds_read_b64_tr_b16 v[16:17], v6 offset:27776
  ds_read_b64_tr_b16 v[18:19], v6 offset:28544
  v_mfma_f32_32x32x16_bf16 v[48:63], v[28:31], v[148:151], v[48:63]
  ds_read_b32 v137, v2 offset:0
  ds_read_b64_tr_b16 v[20:21], v6 offset:40064
  ds_read_b64_tr_b16 v[22:23], v6 offset:40832
  s_waitcnt lgkmcnt(5)
  v_mfma_f32_32x32x16_bf16 v[64:79], v[8:11], v[148:151], v[64:79]
  ds_read_b64_tr_b16 v[24:25], v6 offset:30720
  ds_read_b64_tr_b16 v[26:27], v6 offset:31488
  v_mfma_f32_32x32x16_bf16 v[80:95], v[12:15], v[148:151], v[80:95]
  ds_read_b64_tr_b16 v[28:29], v6 offset:43008
  ds_read_b64_tr_b16 v[30:31], v6 offset:43776
  s_waitcnt lgkmcnt(4)
  v_mfma_f32_32x32x16_bf16 v[96:111], v[16:19], v[148:151], v[96:111]
  ds_read_b64_tr_b16 v[8:9], v6 offset:30784
  ds_read_b64_tr_b16 v[10:11], v6 offset:31552
  v_mfma_f32_32x32x16_bf16 v[112:127], v[20:23], v[148:151], v[112:127]
  ds_read_b64_tr_b16 v[12:13], v6 offset:43072
  ds_read_b64_tr_b16 v[14:15], v6 offset:43840
  s_waitcnt lgkmcnt(4)
  v_mfma_f32_32x32x16_bf16 v[32:47], v[24:27], v[152:155], v[32:47]
  ds_read_b64_tr_b16 v[16:17], v6 offset:30848
  ds_read_b64_tr_b16 v[18:19], v6 offset:31616
  v_mfma_f32_32x32x16_bf16 v[48:63], v[28:31], v[152:155], v[48:63]
  v_cmp_gt_u32 vcc, 6, v137
  s_cbranch_vccnz L_slow_chk6
L_back_chk6:
  s_add_u32 m0, s94, 0
  s_mul_i32 s100, s84, 1376
  buffer_load_dwordx4 v128, s[56:59], s100 offen lds
  ds_read_b64_tr_b16 v[20:21], v6 offset:43136
  ds_read_b64_tr_b16 v[22:23], v6 offset:43904
  s_waitcnt lgkmcnt(4)
  v_mfma_f32_32x32x16_bf16 v[64:79], v[8:11], v[152:155], v[64:79]
  ds_read_b32 v3, v2 offset:16
  ds_read_b64_tr_b16 v[24:25], v6 offset:33792
  ds_read_b64_tr_b16 v[26:27], v6 offset:34560
  v_mfma_f32_32x32x16_bf16 v[80:95], v[12:15], v[152:155], v[80:95]
  buffer_load_dwordx4 v129, s[56:59], s100 offen offset:1024 lds
  ds_read_b64_tr_b16 v[28:29], v6 offset:46080
  ds_read_b64_tr_b16 v[30:31], v6 offset:46848
  s_waitcnt lgkmcnt(5)
  v_mfma_f32_32x32x16_bf16 v[96:111], v[16:19], v[152:155], v[96:111]
  ds_read_b64_tr_b16 v[8:9], v6 offset:33856
  ds_read_b64_tr_b16 v[10:11], v6 offset:34624
  v_mfma_f32_32x32x16_bf16 v[112:127], v[20:23], v[152:155], v[112:127]
  ds_read_b64_tr_b16 v[12:13], v6 offset:46144
  ds_read_b64_tr_b16 v[14:15], v6 offset:46912
  s_waitcnt lgkmcnt(4)
  v_mfma_f32_32x32x16_bf16 v[32:47], v[24:27], v[156:159], v[32:47]
  buffer_load_dwordx4 v130, s[56:59], s100 offen offset:2048 lds
  ds_read_b64_tr_b16 v[16:17], v6 offset:33920
  ds_read_b64_tr_b16 v[18:19], v6 offset:34688
  v_mfma_f32_32x32x16_bf16 v[48:63], v[28:31], v[156:159], v[48:63]
  ds_read_b64_tr_b16 v[20:21], v6 offset:46208
  ds_read_b64_tr_b16 v[22:23], v6 offset:46976
  s_waitcnt lgkmcnt(4)
  v_mfma_f32_32x32x16_bf16 v[64:79], v[8:11], v[156:159], v[64:79]
  s_add_u32 m0, s94, 3072
  s_add_u32 s100, s100, 44032
  buffer_load_dwordx4 v128, s[56:59], s100 offen lds
  v_cmp_gt_u32 vcc, 7, v3
  s_cbranch_vccnz L_slow_chk7
L_back_chk7:
  v_add_u32 v6, 49152, v6
  ds_read_b64_tr_b16 v[24:25], v6 offset:0
  ds_read_b64_tr_b16 v[26:27], v6 offset:768
  v_mfma_f32_32x32x16_bf16 v[80:95], v[12:15], v[156:159], v[80:95]
  ds_read_b128 v[132:135], v136 offset:1024
  ds_read_b64_tr_b16 v[28:29], v6 offset:12288
  ds_read_b64_tr_b16 v[30:31], v6 offset:13056
  s_waitcnt lgkmcnt(5)
  v_mfma_f32_32x32x16_bf16 v[96:111], v[16:19], v[156:159], v[96:111]
  ds_read_b64_tr_b16 v[8:9], v6 offset:64
  ds_read_b64_tr_b16 v[10:11], v6 offset:832
  v_mfma_f32_32x32x16_bf16 v[112:127], v[20:23], v[156:159], v[112:127]
  buffer_load_dwordx4 v129, s[56:59], s100 offen offset:1024 lds
  ds_read_b64_tr_b16 v[12:13], v6 offset:12352
  ds_read_b64_tr_b16 v[14:15], v6 offset:13120
  s_waitcnt lgkmcnt(4)
  v_mfma_f32_32x32x16_bf16 v[32:47], v[24:27], v[160:163], v[32:47]
  ds_read_b64_tr_b16 v[16:17], v6 offset:128
  ds_read_b64_tr_b16 v[18:19], v6 offset:896
  v_mfma_f32_32x32x16_bf16 v[48:63], v[28:31], v[160:163], v[48:63]
  v_mov_b32 v4, 7
  ds_write_b32 v5, v4 offset:0
  buffer_load_dwordx4 v130, s[56:59], s100 offen offset:2048 lds
  ds_read_b64_tr_b16 v[20:21], v6 offset:12416
  ds_read_b64_tr_b16 v[22:23], v6 offset:13184
  s_waitcnt lgkmcnt(5)
  v_mfma_f32_32x32x16_bf16 v[64:79], v[8:11], v[160:163], v[64:79]
  ds_read_b64_tr_b16 v[24:25], v6 offset:3072
  ds_read_b64_tr_b16 v[26:27], v6 offset:3840
  v_mfma_f32_32x32x16_bf16 v[80:95], v[12:15], v[160:163], v[80:95]
  ds_read_b64_tr_b16 v[28:29], v6 offset:15360
  ds_read_b64_tr_b16 v[30:31], v6 offset:16128
  s_waitcnt lgkmcnt(4)
  v_mfma_f32_32x32x16_bf16 v[96:111], v[16:19], v[160:163], v[96:111]
  s_add_u32 m0, s94, 98304
  s_mul_i32 s100, s86, 1376
  buffer_load_dwordx4 v128, s[56:59], s100 offen lds
  ds_read_b64_tr_b16 v[8:9], v6 offset:3136
  ds_read_b64_tr_b16 v[10:11], v6 offset:3904
  v_mfma_f32_32x32x16_bf16 v[112:127], v[20:23], v[160:163], v[112:127]
  ds_read_b64_tr_b16 v[12:13], v6 offset:15424
  ds_read_b64_tr_b16 v[14:15], v6 offset:16192
  s_waitcnt lgkmcnt(4)
  v_mfma_f32_32x32x16_bf16 v[32:47], v[24:27], v[164:167], v[32:47]
  buffer_load_dwordx4 v129, s[56:59], s100 offen offset:1024 lds
  ds_read_b64_tr_b16 v[16:17], v6 offset:3200
  ds_read_b64_tr_b16 v[18:19], v6 offset:3968
  v_mfma_f32_32x32x16_bf16 v[48:63], v[28:31], v[164:167], v[48:63]
  ds_read_b64_tr_b16 v[20:21], v6 offset:15488
  ds_read_b64_tr_b16 v[22:23], v6 offset:16256
  s_waitcnt lgkmcnt(4)
  v_mfma_f32_32x32x16_bf16 v[64:79], v[8:11], v[164:167], v[64:79]
  buffer_load_dwordx4 v130, s[56:59], s100 offen offset:2048 lds
  ds_read_b64_tr_b16 v[24:25], v6 offset:6144
  ds_read_b64_tr_b16 v[26:27], v6 offset:6912
  v_mfma_f32_32x32x16_bf16 v[80:95], v[12:15], v[164:167], v[80:95]
  ds_read_b64_tr_b16 v[28:29], v6 offset:18432
  ds_read_b64_tr_b16 v[30:31], v6 offset:19200
  s_waitcnt lgkmcnt(4)
  v_mfma_f32_32x32x16_bf16 v[96:111], v[16:19], v[164:167], v[96:111]
  s_add_u32 m0, s94, 101376
  s_add_u32 s100, s100, 44032
  buffer_load_dwordx4 v128, s[56:59], s100 offen lds
  ds_read_b32 v137, v2 offset:0
  ds_read_b64_tr_b16 v[8:9], v6 offset:6208
  ds_read_b64_tr_b16 v[10:11], v6 offset:6976
  v_mfma_f32_32x32x16_bf16 v[112:127], v[20:23], v[164:167], v[112:127]
  ds_read_b64_tr_b16 v[12:13], v6 offset:18496
  ds_read_b64_tr_b16 v[14:15], v6 offset:19264
  s_waitcnt lgkmcnt(5)
  v_mfma_f32_32x32x16_bf16 v[32:47], v[24:27], v[168:171], v[32:47]
  buffer_load_dwordx4 v129, s[56:59], s100 offen offset:1024 lds
  ds_read_b64_tr_b16 v[16:17], v6 offset:6272
  ds_read_b64_tr_b16 v[18:19], v6 offset:7040
  v_mfma_f32_32x32x16_bf16 v[48:63], v[28:31], v[168:171], v[48:63]
  ds_read_b64_tr_b16 v[20:21], v6 offset:18560
  ds_read_b64_tr_b16 v[22:23], v6 offset:19328
  s_waitcnt lgkmcnt(4)
  v_mfma_f32_32x32x16_bf16 v[64:79], v[8:11], v[168:171], v[64:79]
  ds_read_b32 v3, v2 offset:16
  buffer_load_dwordx4 v130, s[56:59], s100 offen offset:2048 lds
  ds_read_b64_tr_b16 v[24:25], v6 offset:9216
  ds_read_b64_tr_b16 v[26:27], v6 offset:9984
  v_mfma_f32_32x32x16_bf16 v[80:95], v[12:15], v[168:171], v[80:95]
  ds_read_b64_tr_b16 v[28:29], v6 offset:21504
  ds_read_b64_tr_b16 v[30:31], v6 offset:22272
  s_waitcnt lgkmcnt(5)
  v_mfma_f32_32x32x16_bf16 v[96:111], v[16:19], v[168:171], v[96:111]
  v_cmp_gt_u32 vcc, 7, v137
  s_cbranch_vccnz L_slow_chk8
L_back_chk8:
  s_add_u32 m0, s94, 24576
  s_mul_i32 s100, s85, 1376
  buffer_load_dwordx4 v128, s[56:59], s100 offen lds
  ds_read_b64_tr_b16 v[8:9], v6 offset:9280
  ds_read_b64_tr_b16 v[10:11], v6 offset:10048
  v_mfma_f32_32x32x16_bf16 v[112:127], v[20:23], v[168:171], v[112:127]
  ds_read_b64_tr_b16 v[12:13], v6 offset:21568
  ds_read_b64_tr_b16 v[14:15], v6 offset:22336
  s_waitcnt lgkmcnt(4)
  v_mfma_f32_32x32x16_bf16 v[32:47], v[24:27], v[172:175], v[32:47]
  buffer_load_dwordx4 v129, s[56:59], s100 offen offset:1024 lds
  ds_read_b64_tr_b16 v[16:17], v6 offset:9344
  ds_read_b64_tr_b16 v[18:19], v6 offset:10112
  v_mfma_f32_32x32x16_bf16 v[48:63], v[28:31], v[172:175], v[48:63]
  ds_read_b64_tr_b16 v[20:21], v6 offset:21632
  ds_read_b64_tr_b16 v[22:23], v6 offset:22400
  s_waitcnt lgkmcnt(4)
  v_mfma_f32_32x32x16_bf16 v[64:79], v[8:11], v[172:175], v[64:79]
  buffer_load_dwordx4 v130, s[56:59], s100 offen offset:2048 lds
  v_cmp_gt_u32 vcc, 8, v3
  s_cbranch_vccnz L_slow_chk9
L_back_chk9:
  ds_read_b64_tr_b16 v[24:25], v6 offset:24576
  ds_read_b64_tr_b16 v[26:27], v6 offset:25344
  v_mfma_f32_32x32x16_bf16 v[80:95], v[12:15], v[172:175], v[80:95]
  ds_read_b64_tr_b16 v[28:29], v6 offset:36864
  ds_read_b64_tr_b16 v[30:31], v6 offset:37632
  s_waitcnt lgkmcnt(4)
  v_mfma_f32_32x32x16_bf16 v[96:111], v[16:19], v[172:175], v[96:111]
  s_add_u32 m0, s94, 27648
  s_add_u32 s100, s100, 44032
  buffer_load_dwordx4 v128, s[56:59], s100 offen lds
  ds_read_b64_tr_b16 v[8:9], v6 offset:24640
  ds_read_b64_tr_b16 v[10:11], v6 offset:25408
  v_mfma_f32_32x32x16_bf16 v[112:127], v[20:23], v[172:175], v[112:127]
  ds_read_b64_tr_b16 v[12:13], v6 offset:36928
  ds_read_b64_tr_b16 v[14:15], v6 offset:37696
  s_waitcnt lgkmcnt(4)
  v_mfma_f32_32x32x16_bf16 v[32:47], v[24:27], v[176:179], v[32:47]
  buffer_load_dwordx4 v129, s[56:59], s100 offen offset:1024 lds
  ds_read_b64_tr_b16 v[16:17], v6 offset:24704
  ds_read_b64_tr_b16 v[18:19], v6 offset:25472
  v_mfma_f32_32x32x16_bf16 v[48:63], v[28:31], v[176:179], v[48:63]
  ds_read_b64_tr_b16 v[20:21], v6 offset:36992
  ds_read_b64_tr_b16 v[22:23], v6 offset:37760
  s_waitcnt lgkmcnt(4)
  v_mfma_f32_32x32x16_bf16 v[64:79], v[8:11], v[176:179], v[64:79]
  s_waitcnt vmcnt(11)
  v_mov_b32 v4, 8
  ds_write_b32 v5, v4 offset:0
  buffer_load_dwordx4 v130, s[56:59], s100 offen offset:2048 lds
  ds_read_b64_tr_b16 v[24:25], v6 offset:27648
  ds_read_b64_tr_b16 v[26:27], v6 offset:28416
  v_mfma_f32_32x32x16_bf16 v[80:95], v[12:15], v[176:179], v[80:95]
  ds_read_b64_tr_b16 v[28:29], v6 offset:39936
  ds_read_b64_tr_b16 v[30:31], v6 offset:40704
  s_waitcnt lgkmcnt(5)
  v_mfma_f32_32x32x16_bf16 v[96:111], v[16:19], v[176:179], v[96:111]
  ds_read_b64_tr_b16 v[8:9], v6 offset:27712
  ds_read_b64_tr_b16 v[10:11], v6 offset:28480
  v_readfirstlane_b32 s90, v135
  v_mov_b32 v168, v134
  v_add_u32 v169, 7168, v134
  v_add_u32 v170, 14336, v134
  v_mfma_f32_32x32x16_bf16 v[112:127], v[20:23], v[176:179], v[112:127]
  s_add_u32 m0, s94, 122880
  s_mul_i32 s100, s87, 1376
  buffer_load_dwordx4 v128, s[56:59], s100 offen lds
  ds_read_b64_tr_b16 v[12:13], v6 offset:40000
  ds_read_b64_tr_b16 v[14:15], v6 offset:40768
  s_waitcnt lgkmcnt(4)
  v_mfma_f32_32x32x16_bf16 v[32:47], v[24:27], v[180:183], v[32:47]
  ds_read_b64_tr_b16 v[16:17], v6 offset:27776
  ds_read_b64_tr_b16 v[18:19], v6 offset:28544
  v_add_u32 v171, 21504, v134
  v_add_u32 v134, 14336, v132
  v_add_u32 v135, 14336, v133
  s_add_u32 s95, s6, s101
  v_mfma_f32_32x32x16_bf16 v[48:63], v[28:31], v[180:183], v[48:63]
  buffer_load_dwordx4 v129, s[56:59], s100 offen offset:1024 lds
  ds_read_b64_tr_b16 v[20:21], v6 offset:40064
  ds_read_b64_tr_b16 v[22:23], v6 offset:40832
  s_mul_i32 s52, s7, 49152
  s_add_u32 s52, s52, 65536
  s_waitcnt lgkmcnt(4)
  v_mfma_f32_32x32x16_bf16 v[64:79], v[8:11], v[180:183], v[64:79]
  ds_read_b64_tr_b16 v[24:25], v6 offset:30720
  ds_read_b64_tr_b16 v[26:27], v6 offset:31488
  v_mfma_f32_32x32x16_bf16 v[80:95], v[12:15], v[180:183], v[80:95]
  ds_read_b64_tr_b16 v[28:29], v6 offset:43008
  ds_read_b64_tr_b16 v[30:31], v6 offset:43776
  s_waitcnt lgkmcnt(4)
  v_mfma_f32_32x32x16_bf16 v[96:111], v[16:19], v[180:183], v[96:111]
  buffer_load_dwordx4 v130, s[56:59], s100 offen offset:2048 lds
  ds_read_b64_tr_b16 v[8:9], v6 offset:30784
  ds_read_b64_tr_b16 v[10:11], v6 offset:31552
  v_mfma_f32_32x32x16_bf16 v[112:127], v[20:23], v[180:183], v[112:127]
  ds_read_b64_tr_b16 v[12:13], v6 offset:43072
  ds_read_b64_tr_b16 v[14:15], v6 offset:43840
  s_waitcnt lgkmcnt(4)
  v_mfma_f32_32x32x16_bf16 v[32:47], v[24:27], v[184:187], v[32:47]
  s_add_u32 m0, s94, 125952
  s_add_u32 s100, s100, 44032
  buffer_load_dwordx4 v128, s[56:59], s100 offen lds
  ds_read_b64_tr_b16 v[16:17], v6 offset:30848
  ds_read_b64_tr_b16 v[18:19], v6 offset:31616
  v_mfma_f32_32x32x16_bf16 v[48:63], v[28:31], v[184:187], v[48:63]
  ds_read_b64_tr_b16 v[20:21], v6 offset:43136
  ds_read_b64_tr_b16 v[22:23], v6 offset:43904
  s_waitcnt lgkmcnt(4)
  v_mfma_f32_32x32x16_bf16 v[64:79], v[8:11], v[184:187], v[64:79]
  ds_read_b32 v3, v2 offset:0
  ds_read_b64_tr_b16 v[24:25], v6 offset:33792
  ds_read_b64_tr_b16 v[26:27], v6 offset:34560
  v_mfma_f32_32x32x16_bf16 v[80:95], v[12:15], v[184:187], v[80:95]
  buffer_load_dwordx4 v129, s[56:59], s100 offen offset:1024 lds
  ds_read_b64_tr_b16 v[28:29], v6 offset:46080
  ds_read_b64_tr_b16 v[30:31], v6 offset:46848
  s_waitcnt lgkmcnt(5)
  v_mfma_f32_32x32x16_bf16 v[96:111], v[16:19], v[184:187], v[96:111]
  ds_read_b64_tr_b16 v[8:9], v6 offset:33856
  ds_read_b64_tr_b16 v[10:11], v6 offset:34624
  v_mfma_f32_32x32x16_bf16 v[112:127], v[20:23], v[184:187], v[112:127]
  buffer_load_dwordx4 v130, s[56:59], s100 offen offset:2048 lds
  ds_read_b64_tr_b16 v[12:13], v6 offset:46144
  ds_read_b64_tr_b16 v[14:15], v6 offset:46912
  s_waitcnt lgkmcnt(4)
  v_mfma_f32_32x32x16_bf16 v[32:47], v[24:27], v[188:191], v[32:47]
  ds_read_b64_tr_b16 v[16:17], v6 offset:33920
  ds_read_b64_tr_b16 v[18:19], v6 offset:34688
  v_mfma_f32_32x32x16_bf16 v[48:63], v[28:31], v[188:191], v[48:63]
  ds_read_b64_tr_b16 v[20:21], v6 offset:46208
  ds_read_b64_tr_b16 v[22:23], v6 offset:46976
  s_waitcnt lgkmcnt(4)
  v_mfma_f32_32x32x16_bf16 v[64:79], v[8:11], v[188:191], v[64:79]
  v_cmp_gt_u32 vcc, 8, v3
  s_cbranch_vccnz L_slow_chk10
L_back_chk10:
  v_add_u32 v6, 4294918144, v6
  ds_read_b64_tr_b16 v[24:25], v6 offset:0
  ds_read_b64_tr_b16 v[26:27], v6 offset:768
  v_mfma_f32_32x32x16_bf16 v[80:95], v[12:15], v[188:191], v[80:95]
  s_add_u32 m0, s88, 49152
  s_add_u32 s100, s95, 1
  s_and_b32 s100, s100, 3
  s_lshl2_add_u32 s100, s7, s100
  s_lshl_b32 s100, s100, 7
  buffer_load_dwordx4 v132, s[60:63], s100 offen lds
  ds_read_b64_tr_b16 v[28:29], v6 offset:12288
  ds_read_b64_tr_b16 v[30:31], v6 offset:13056
  s_waitcnt lgkmcnt(4)
  v_mfma_f32_32x32x16_bf16 v[96:111], v[16:19], v[188:191], v[96:111]
  ds_read_b64_tr_b16 v[8:9], v6 offset:64
  ds_read_b64_tr_b16 v[10:11], v6 offset:832
  v_mfma_f32_32x32x16_bf16 v[112:127], v[20:23], v[188:191], v[112:127]
  buffer_load_dwordx4 v133, s[60:63], s100 offen offset:1024 lds
  ds_read_b64_tr_b16 v[12:13], v6 offset:12352
  ds_read_b64_tr_b16 v[14:15], v6 offset:13120
  s_waitcnt lgkmcnt(4)
  v_mfma_f32_32x32x16_bf16 v[32:47], v[24:27], v[192:195], v[32:47]
  ds_read_b64_tr_b16 v[16:17], v6 offset:128
  ds_read_b64_tr_b16 v[18:19], v6 offset:896
  v_mfma_f32_32x32x16_bf16 v[48:63], v[28:31], v[192:195], v[48:63]
  buffer_load_dwordx4 v134, s[60:63], s100 offen offset:2048 lds
  ds_read_b64_tr_b16 v[20:21], v6 offset:12416
  ds_read_b64_tr_b16 v[22:23], v6 offset:13184
  s_waitcnt lgkmcnt(4)
  v_mfma_f32_32x32x16_bf16 v[64:79], v[8:11], v[192:195], v[64:79]
  ds_read_b64_tr_b16 v[24:25], v6 offset:3072
  ds_read_b64_tr_b16 v[26:27], v6 offset:3840
  v_mfma_f32_32x32x16_bf16 v[80:95], v[12:15], v[192:195], v[80:95]
  s_waitcnt vmcnt(9)
  v_mov_b32 v4, 9
  ds_write_b32 v5, v4 offset:0
  buffer_load_dwordx4 v135, s[60:63], s100 offen offset:3072 lds
  ds_read_b64_tr_b16 v[28:29], v6 offset:15360
  ds_read_b64_tr_b16 v[30:31], v6 offset:16128
  s_waitcnt lgkmcnt(5)
  v_mfma_f32_32x32x16_bf16 v[96:111], v[16:19], v[192:195], v[96:111]
  ds_read_b64_tr_b16 v[8:9], v6 offset:3136
  ds_read_b64_tr_b16 v[10:11], v6 offset:3904
  v_mfma_f32_32x32x16_bf16 v[112:127], v[20:23], v[192:195], v[112:127]
  ds_read_b64_tr_b16 v[12:13], v6 offset:15424
  ds_read_b64_tr_b16 v[14:15], v6 offset:16192
  s_waitcnt lgkmcnt(4)
  v_mfma_f32_32x32x16_bf16 v[32:47], v[24:27], v[196:199], v[32:47]
  ds_read_b64_tr_b16 v[16:17], v6 offset:3200
  ds_read_b64_tr_b16 v[18:19], v6 offset:3968
  v_mfma_f32_32x32x16_bf16 v[48:63], v[28:31], v[196:199], v[48:63]
  ds_read_b64_tr_b16 v[20:21], v6 offset:15488
  ds_read_b64_tr_b16 v[22:23], v6 offset:16256
  s_waitcnt lgkmcnt(4)
  v_mfma_f32_32x32x16_bf16 v[64:79], v[8:11], v[196:199], v[64:79]
  ds_read_b64_tr_b16 v[24:25], v6 offset:6144
  ds_read_b64_tr_b16 v[26:27], v6 offset:6912
  v_mfma_f32_32x32x16_bf16 v[80:95], v[12:15], v[196:199], v[80:95]
  ds_read_b64_tr_b16 v[28:29], v6 offset:18432
  ds_read_b64_tr_b16 v[30:31], v6 offset:19200
  s_waitcnt lgkmcnt(4)
  v_mfma_f32_32x32x16_bf16 v[96:111], v[16:19], v[196:199], v[96:111]
  ds_read_b64_tr_b16 v[8:9], v6 offset:6208
  ds_read_b64_tr_b16 v[10:11], v6 offset:6976
  v_mfma_f32_32x32x16_bf16 v[112:127], v[20:23], v[196:199], v[112:127]
  ds_read_b64_tr_b16 v[12:13], v6 offset:18496
  ds_read_b64_tr_b16 v[14:15], v6 offset:19264
  s_waitcnt lgkmcnt(4)
  v_mfma_f32_32x32x16_bf16 v[32:47], v[24:27], v[200:203], v[32:47]
  ds_read_b64_tr_b16 v[16:17], v6 offset:6272
  ds_read_b64_tr_b16 v[18:19], v6 offset:7040
  v_mfma_f32_32x32x16_bf16 v[48:63], v[28:31], v[200:203], v[48:63]
  ds_read_b64_tr_b16 v[20:21], v6 offset:18560
  ds_read_b64_tr_b16 v[22:23], v6 offset:19328
  s_waitcnt lgkmcnt(4)
  v_mfma_f32_32x32x16_bf16 v[64:79], v[8:11], v[200:203], v[64:79]
  ds_read_b32 v3, v2 offset:0
  ds_read_b64_tr_b16 v[24:25], v6 offset:9216
  ds_read_b64_tr_b16 v[26:27], v6 offset:9984
  v_mfma_f32_32x32x16_bf16 v[80:95], v[12:15], v[200:203], v[80:95]
  ds_read_b64_tr_b16 v[28:29], v6 offset:21504
  ds_read_b64_tr_b16 v[30:31], v6 offset:22272
  s_waitcnt lgkmcnt(5)
  v_mfma_f32_32x32x16_bf16 v[96:111], v[16:19], v[200:203], v[96:111]
  ds_read_b64_tr_b16 v[8:9], v6 offset:9280
  ds_read_b64_tr_b16 v[10:11], v6 offset:10048
  v_mfma_f32_32x32x16_bf16 v[112:127], v[20:23], v[200:203], v[112:127]
  ds_read_b64_tr_b16 v[12:13], v6 offset:21568
  ds_read_b64_tr_b16 v[14:15], v6 offset:22336
  s_waitcnt lgkmcnt(4)
  v_mfma_f32_32x32x16_bf16 v[32:47], v[24:27], v[204:207], v[32:47]
  ds_read_b64_tr_b16 v[16:17], v6 offset:9344
  ds_read_b64_tr_b16 v[18:19], v6 offset:10112
  v_mfma_f32_32x32x16_bf16 v[48:63], v[28:31], v[204:207], v[48:63]
  ds_read_b64_tr_b16 v[20:21], v6 offset:21632
  ds_read_b64_tr_b16 v[22:23], v6 offset:22400
  s_waitcnt lgkmcnt(4)
  v_mfma_f32_32x32x16_bf16 v[64:79], v[8:11], v[204:207], v[64:79]
  v_cmp_gt_u32 vcc, 9, v3
  s_cbranch_vccnz L_slow_chk11
L_back_chk11:
  ds_read_b64_tr_b16 v[24:25], v6 offset:24576
  ds_read_b64_tr_b16 v[26:27], v6 offset:25344
  v_mfma_f32_32x32x16_bf16 v[80:95], v[12:15], v[204:207], v[80:95]
  s_add_u32 m0, s88, 65536
  s_add_u32 s100, s95, 2
  s_and_b32 s100, s100, 3
  s_lshl2_add_u32 s100, s7, s100
  s_lshl_b32 s100, s100, 7
  buffer_load_dwordx4 v132, s[60:63], s100 offen lds
  ds_read_b64_tr_b16 v[28:29], v6 offset:36864
  ds_read_b64_tr_b16 v[30:31], v6 offset:37632
  s_waitcnt lgkmcnt(4)
  v_mfma_f32_32x32x16_bf16 v[96:111], v[16:19], v[204:207], v[96:111]
  ds_read_b64_tr_b16 v[8:9], v6 offset:24640
  ds_read_b64_tr_b16 v[10:11], v6 offset:25408
  v_mfma_f32_32x32x16_bf16 v[112:127], v[20:23], v[204:207], v[112:127]
  buffer_load_dwordx4 v133, s[60:63], s100 offen offset:1024 lds
  ds_read_b64_tr_b16 v[12:13], v6 offset:36928
  ds_read_b64_tr_b16 v[14:15], v6 offset:37696
  s_waitcnt lgkmcnt(4)
  v_mfma_f32_32x32x16_bf16 v[32:47], v[24:27], v[208:211], v[32:47]
  ds_read_b64_tr_b16 v[16:17], v6 offset:24704
  ds_read_b64_tr_b16 v[18:19], v6 offset:25472
  s_lshl2_add_u32 s9, s4, s3
  s_mul_i32 s9, s9, 163840
  v_lshl_add_u32 v138, v1, 4, s9
  s_lshl_b32 s9, s6, 11
  v_mfma_f32_32x32x16_bf16 v[48:63], v[28:31], v[208:211], v[48:63]
  buffer_load_dwordx4 v134, s[60:63], s100 offen offset:2048 lds
  ds_read_b64_tr_b16 v[20:21], v6 offset:36992
  ds_read_b64_tr_b16 v[22:23], v6 offset:37760
  s_add_u32 s9, s9, s52
  s_add_u32 s16, s9, 0
  s_waitcnt lgkmcnt(4)
  v_mfma_f32_32x32x16_bf16 v[64:79], v[8:11], v[208:211], v[64:79]
  s_waitcnt vmcnt(7)
  v_mov_b32 v4, 10
  ds_write_b32 v5, v4 offset:0
  ds_read_b64_tr_b16 v[24:25], v6 offset:27648
  ds_read_b64_tr_b16 v[26:27], v6 offset:28416
  s_add_u32 s17, s9, 16384
  v_mfma_f32_32x32x16_bf16 v[80:95], v[12:15], v[208:211], v[80:95]
  buffer_load_dwordx4 v135, s[60:63], s100 offen offset:3072 lds
  ds_read_b64_tr_b16 v[28:29], v6 offset:39936
  ds_read_b64_tr_b16 v[30:31], v6 offset:40704
  s_add_u32 s18, s9, 32768
  s_cmp_eq_u32 s6, 7
  s_cselect_b32 s17, 0x40000000, s17
  s_cselect_b32 s18, 0x40000000, s18
  s_waitcnt lgkmcnt(5)
  v_mfma_f32_32x32x16_bf16 v[96:111], v[16:19], v[208:211], v[96:111]
  ds_read_b64_tr_b16 v[8:9], v6 offset:27712
  ds_read_b64_tr_b16 v[10:11], v6 offset:28480
  s_cmp_eq_u32 s5, 15
  s_cselect_b32 s16, 0x40000000, s16
  s_and_b32 s10, s3, 1
  s_lshr_b32 s11, s3, 1
  v_mfma_f32_32x32x16_bf16 v[112:127], v[20:23], v[208:211], v[112:127]
  s_add_u32 m0, s88, 81920
  s_add_u32 s100, s95, 3
  s_and_b32 s100, s100, 3
  s_lshl2_add_u32 s100, s7, s100
  s_lshl_b32 s100, s100, 7
  buffer_load_dwordx4 v132, s[60:63], s100 offen lds
  ds_read_b64_tr_b16 v[12:13], v6 offset:40000
  ds_read_b64_tr_b16 v[14:15], v6 offset:40768
  s_waitcnt lgkmcnt(4)
  v_mfma_f32_32x32x16_bf16 v[32:47], v[24:27], v[212:215], v[32:47]
  ds_read_b64_tr_b16 v[16:17], v6 offset:27776
  ds_read_b64_tr_b16 v[18:19], v6 offset:28544
  s_lshl1_add_u32 s9, s4, s7
  s_lshl1_add_u32 s9, s9, s11
  s_mul_i32 s9, s9, 163840
  s_lshl_b32 s12, s10, 12
  v_mfma_f32_32x32x16_bf16 v[48:63], v[28:31], v[212:215], v[48:63]
  buffer_load_dwordx4 v133, s[60:63], s100 offen offset:1024 lds
  ds_read_b64_tr_b16 v[20:21], v6 offset:40064
  ds_read_b64_tr_b16 v[22:23], v6 offset:40832
  s_add_u32 s9, s9, s12
  v_lshl_add_u32 v139, v1, 4, s9
  s_waitcnt lgkmcnt(4)
  v_mfma_f32_32x32x16_bf16 v[64:79], v[8:11], v[212:215], v[64:79]
  ds_read_b64_tr_b16 v[24:25], v6 offset:30720
  ds_read_b64_tr_b16 v[26:27], v6 offset:31488
  v_lshlrev_b32 v140, 16, v131
  s_mul_i32 s9, s7, 655360
  s_sub_u32 s9, 327680, s9
  v_add_u32 v7, s9, v139
  v_mfma_f32_32x32x16_bf16 v[80:95], v[12:15], v[212:215], v[80:95]
  buffer_load_dwordx4 v134, s[60:63], s100 offen offset:2048 lds
  ds_read_b64_tr_b16 v[28:29], v6 offset:43008
  ds_read_b64_tr_b16 v[30:31], v6 offset:43776
  s_lshl_b32 s54, s7, 1
  s_or_b32 s54, s54, 40
  s_waitcnt lgkmcnt(4)
  v_mfma_f32_32x32x16_bf16 v[96:111], v[16:19], v[212:215], v[96:111]
  ds_read_b64_tr_b16 v[8:9], v6 offset:30784
  ds_read_b64_tr_b16 v[10:11], v6 offset:31552
  s_mul_i32 s54, s54, s10
  v_mfma_f32_32x32x16_bf16 v[112:127], v[20:23], v[212:215], v[112:127]
  buffer_load_dwordx4 v135, s[60:63], s100 offen offset:3072 lds
  ds_read_b64_tr_b16 v[12:13], v6 offset:43072
  ds_read_b64_tr_b16 v[14:15], v6 offset:43840
  s_waitcnt lgkmcnt(4)
  v_mfma_f32_32x32x16_bf16 v[32:47], v[24:27], v[216:219], v[32:47]
  ds_read_b64_tr_b16 v[16:17], v6 offset:30848
  ds_read_b64_tr_b16 v[18:19], v6 offset:31616
  v_mfma_f32_32x32x16_bf16 v[48:63], v[28:31], v[216:219], v[48:63]
  ds_read_b64_tr_b16 v[20:21], v6 offset:43136
  ds_read_b64_tr_b16 v[22:23], v6 offset:43904
  s_waitcnt lgkmcnt(4)
  v_mfma_f32_32x32x16_bf16 v[64:79], v[8:11], v[216:219], v[64:79]
  ds_read_b32 v3, v2 offset:0
  ds_read_b64_tr_b16 v[24:25], v6 offset:33792
  ds_read_b64_tr_b16 v[26:27], v6 offset:34560
  v_mfma_f32_32x32x16_bf16 v[80:95], v[12:15], v[216:219], v[80:95]
  ds_read_b64_tr_b16 v[28:29], v6 offset:46080
  ds_read_b64_tr_b16 v[30:31], v6 offset:46848
  s_waitcnt lgkmcnt(5)
  v_mfma_f32_32x32x16_bf16 v[96:111], v[16:19], v[216:219], v[96:111]
  ds_read_b64_tr_b16 v[8:9], v6 offset:33856
  ds_read_b64_tr_b16 v[10:11], v6 offset:34624
  v_mfma_f32_32x32x16_bf16 v[112:127], v[20:23], v[216:219], v[112:127]
  ds_read_b64_tr_b16 v[12:13], v6 offset:46144
  ds_read_b64_tr_b16 v[14:15], v6 offset:46912
  s_waitcnt lgkmcnt(4)
  v_mfma_f32_32x32x16_bf16 v[32:47], v[24:27], v[220:223], v[32:47]
  ds_read_b64_tr_b16 v[16:17], v6 offset:33920
  ds_read_b64_tr_b16 v[18:19], v6 offset:34688
  v_mfma_f32_32x32x16_bf16 v[48:63], v[28:31], v[220:223], v[48:63]
  ds_read_b64_tr_b16 v[20:21], v6 offset:46208
  ds_read_b64_tr_b16 v[22:23], v6 offset:46976
  s_waitcnt lgkmcnt(4)
  v_mfma_f32_32x32x16_bf16 v[64:79], v[8:11], v[220:223], v[64:79]
  v_cmp_gt_u32 vcc, 10, v3
  s_cbranch_vccnz L_slow_chk12
L_back_chk12:
  v_add_u32 v6, 81920, v6
  ds_read_b64_tr_b16 v[24:25], v6 offset:16384
  ds_read_b64_tr_b16 v[26:27], v6 offset:17152
  v_mfma_f32_32x32x16_bf16 v[80:95], v[12:15], v[220:223], v[80:95]
  s_add_u32 m0, s88, 0
  s_add_u32 s19, s95, 1
  s_and_b32 s19, s19, 3
  s_lshl2_add_u32 s19, s19, s3
  s_and_b32 s100, s19, 7
  s_lshl3_add_u32 s100, s7, s100
  s_mul_i32 s100, s100, 3
  s_lshr_b32 s19, s19, 3
  s_add_u32 s100, s100, s19
  s_sub_u32 s19, s100, 22
  s_cmp_lt_u32 s19, 2
  s_cselect_b32 s100, 64, s100
  s_lshl_b32 s19, s7, 1
  s_sub_u32 s100, s100, s19
  s_lshl_b32 s100, s100, 15
  buffer_load_dwordx4 v168, s[64:67], s100 offen lds
  ds_read_b64_tr_b16 v[28:29], v6 offset:28672
  ds_read_b64_tr_b16 v[30:31], v6 offset:29440
  s_waitcnt lgkmcnt(4)
  v_mfma_f32_32x32x16_bf16 v[96:111], v[16:19], v[220:223], v[96:111]
  ds_read_b64_tr_b16 v[8:9], v6 offset:19456
  ds_read_b64_tr_b16 v[10:11], v6 offset:20224
  v_mfma_f32_32x32x16_bf16 v[112:127], v[20:23], v[220:223], v[112:127]
  buffer_load_dwordx4 v169, s[64:67], s100 offen offset:1024 lds
  ds_read_b64_tr_b16 v[12:13], v6 offset:31744
  ds_read_b64_tr_b16 v[14:15], v6 offset:32512
  s_waitcnt lgkmcnt(4)
  v_mfma_f32_32x32x16_bf16 v[32:47], v[24:27], v[224:227], v[32:47]
  ds_read_b64_tr_b16 v[16:17], v6 offset:22528
  ds_read_b64_tr_b16 v[18:19], v6 offset:23296
  v_mfma_f32_32x32x16_bf16 v[48:63], v[28:31], v[224:227], v[48:63]
  v_mov_b32 v4, 11
  ds_write_b32 v5, v4 offset:0
  buffer_load_dwordx4 v170, s[64:67], s100 offen offset:2048 lds
  ds_read_b64_tr_b16 v[20:21], v6 offset:34816
  ds_read_b64_tr_b16 v[22:23], v6 offset:35584
  s_waitcnt lgkmcnt(5)
  v_mfma_f32_32x32x16_bf16 v[32:47], v[8:11], v[228:231], v[32:47]
  ds_read_b64_tr_b16 v[24:25], v6 offset:25600
  ds_read_b64_tr_b16 v[26:27], v6 offset:26368
  v_mfma_f32_32x32x16_bf16 v[48:63], v[12:15], v[228:231], v[48:63]
  buffer_load_dwordx4 v171, s[64:67], s100 offen offset:3072 lds
  ds_read_b64_tr_b16 v[28:29], v6 offset:37888
  ds_read_b64_tr_b16 v[30:31], v6 offset:38656
  s_waitcnt lgkmcnt(4)
  v_mfma_f32_32x32x16_bf16 v[32:47], v[16:19], v[232:235], v[32:47]
  ds_read_b64_tr_b16 v[8:9], v6 offset:40960
  ds_read_b64_tr_b16 v[10:11], v6 offset:41728
  v_mfma_f32_32x32x16_bf16 v[48:63], v[20:23], v[232:235], v[48:63]
  ds_read_b64_tr_b16 v[12:13], v6 offset:53248
  ds_read_b64_tr_b16 v[14:15], v6 offset:54016
  s_waitcnt lgkmcnt(4)
  v_mfma_f32_32x32x16_bf16 v[32:47], v[24:27], v[236:239], v[32:47]
  ds_read_b64_tr_b16 v[16:17], v6 offset:44032
  ds_read_b64_tr_b16 v[18:19], v6 offset:44800
  v_mfma_f32_32x32x16_bf16 v[48:63], v[28:31], v[236:239], v[48:63]
  ds_read_b64_tr_b16 v[20:21], v6 offset:56320
  ds_read_b64_tr_b16 v[22:23], v6 offset:57088
  s_waitcnt lgkmcnt(4)
  v_mfma_f32_32x32x16_bf16 v[32:47], v[8:11], v[240:243], v[32:47]
  ds_read_b64_tr_b16 v[24:25], v6 offset:47104
  ds_read_b64_tr_b16 v[26:27], v6 offset:47872
  v_mfma_f32_32x32x16_bf16 v[48:63], v[12:15], v[240:243], v[48:63]
  ds_read_b64_tr_b16 v[28:29], v6 offset:59392
  ds_read_b64_tr_b16 v[30:31], v6 offset:60160
  s_waitcnt lgkmcnt(4)
  v_mfma_f32_32x32x16_bf16 v[32:47], v[16:19], v[244:247], v[32:47]
  ds_read_b64_tr_b16 v[8:9], v6 offset:50176
  ds_read_b64_tr_b16 v[10:11], v6 offset:50944
  v_mfma_f32_32x32x16_bf16 v[48:63], v[20:23], v[244:247], v[48:63]
  ds_read_b64_tr_b16 v[12:13], v6 offset:62464
  ds_read_b64_tr_b16 v[14:15], v6 offset:63232
  s_waitcnt lgkmcnt(4)
  v_mfma_f32_32x32x16_bf16 v[32:47], v[24:27], v[248:251], v[32:47]
  ds_read_b64_tr_b16 v[16:17], v6 offset:16448
  ds_read_b64_tr_b16 v[18:19], v6 offset:17216
  v_mfma_f32_32x32x16_bf16 v[48:63], v[28:31], v[248:251], v[48:63]
  ds_read_b64_tr_b16 v[20:21], v6 offset:28736
  ds_read_b64_tr_b16 v[22:23], v6 offset:29504
  s_waitcnt lgkmcnt(4)
  v_mfma_f32_32x32x16_bf16 v[32:47], v[8:11], v[252:255], v[32:47]
  ds_read_b64_tr_b16 v[24:25], v6 offset:19520
  ds_read_b64_tr_b16 v[26:27], v6 offset:20288
  v_mfma_f32_32x32x16_bf16 v[48:63], v[12:15], v[252:255], v[48:63]
  ds_read_b64_tr_b16 v[28:29], v6 offset:31808
  ds_read_b64_tr_b16 v[30:31], v6 offset:32576
  s_waitcnt lgkmcnt(4)
  v_mfma_f32_32x32x16_bf16 v[64:79], v[16:19], v[224:227], v[64:79]
  ds_read_b64_tr_b16 v[8:9], v6 offset:22592
  ds_read_b64_tr_b16 v[10:11], v6 offset:23360
  v_mfma_f32_32x32x16_bf16 v[80:95], v[20:23], v[224:227], v[80:95]
  ds_read_b64_tr_b16 v[12:13], v6 offset:34880
  ds_read_b64_tr_b16 v[14:15], v6 offset:35648
  s_waitcnt lgkmcnt(4)
  v_mfma_f32_32x32x16_bf16 v[64:79], v[24:27], v[228:231], v[64:79]
  ds_read_b64_tr_b16 v[16:17], v6 offset:25664
  ds_read_b64_tr_b16 v[18:19], v6 offset:26432
  v_mul_f32 v48, v0, v48
  v_mul_f32 v49, v0, v49
  v_mul_f32 v48, v32, v48
  v_mul_f32 v49, v33, v49
  v_mfma_f32_32x32x16_bf16 v[80:95], v[28:31], v[228:231], v[80:95]
  ds_read_b64_tr_b16 v[20:21], v6 offset:37952
  ds_read_b64_tr_b16 v[22:23], v6 offset:38720
  v_cvt_pk_bf16_f32 v144, v48, v49
  v_mul_f32 v50, v0, v50
  v_mul_f32 v51, v0, v51
  s_waitcnt lgkmcnt(4)
  v_mfma_f32_32x32x16_bf16 v[64:79], v[8:11], v[232:235], v[64:79]
  ds_read_b64_tr_b16 v[24:25], v6 offset:41024
  ds_read_b64_tr_b16 v[26:27], v6 offset:41792
  v_mul_f32 v50, v34, v50
  v_mul_f32 v51, v35, v51
  v_cvt_pk_bf16_f32 v145, v50, v51
  v_mul_f32 v52, v0, v52
  v_mfma_f32_32x32x16_bf16 v[80:95], v[12:15], v[232:235], v[80:95]
  ds_read_b64_tr_b16 v[28:29], v6 offset:53312
  ds_read_b64_tr_b16 v[30:31], v6 offset:54080
  v_mul_f32 v53, v0, v53
  v_mul_f32 v52, v36, v52
  v_mul_f32 v53, v37, v53
  s_waitcnt lgkmcnt(4)
  v_mfma_f32_32x32x16_bf16 v[64:79], v[16:19], v[236:239], v[64:79]
  ds_read_b64_tr_b16 v[8:9], v6 offset:44096
  ds_read_b64_tr_b16 v[10:11], v6 offset:44864
  v_cvt_pk_bf16_f32 v146, v52, v53
  v_mul_f32 v54, v0, v54
  v_mul_f32 v55, v0, v55
  v_mul_f32 v54, v38, v54
  v_mfma_f32_32x32x16_bf16 v[80:95], v[20:23], v[236:239], v[80:95]
  ds_read_b64_tr_b16 v[12:13], v6 offset:56384
  ds_read_b64_tr_b16 v[14:15], v6 offset:57152
  v_mul_f32 v55, v39, v55
  v_cvt_pk_bf16_f32 v147, v54, v55
  buffer_store_dwordx4 v[144:147], v138, s[68:71], s16 offen offset:0 sc1
  s_waitcnt lgkmcnt(4)
  v_mfma_f32_32x32x16_bf16 v[64:79], v[24:27], v[240:243], v[64:79]
  ds_read_b64_tr_b16 v[16:17], v6 offset:47168
  ds_read_b64_tr_b16 v[18:19], v6 offset:47936
  v_mul_f32 v56, v0, v56
  v_mul_f32 v57, v0, v57
  v_mul_f32 v56, v40, v56
  v_mul_f32 v57, v41, v57
  v_mfma_f32_32x32x16_bf16 v[80:95], v[28:31], v[240:243], v[80:95]
  ds_read_b64_tr_b16 v[20:21], v6 offset:59456
  ds_read_b64_tr_b16 v[22:23], v6 offset:60224
  v_cvt_pk_bf16_f32 v148, v56, v57
  v_mul_f32 v58, v0, v58
  v_mul_f32 v59, v0, v59
  s_waitcnt lgkmcnt(4)
  v_mfma_f32_32x32x16_bf16 v[64:79], v[8:11], v[244:247], v[64:79]
  v_mov_b32 v4, 12
  ds_write_b32 v5, v4 offset:0
  ds_read_b64_tr_b16 v[24:25], v6 offset:50240
  ds_read_b64_tr_b16 v[26:27], v6 offset:51008
  v_mul_f32 v58, v42, v58
  v_mul_f32 v59, v43, v59
  v_mfma_f32_32x32x16_bf16 v[80:95], v[12:15], v[244:247], v[80:95]
  ds_read_b64_tr_b16 v[28:29], v6 offset:62528
  ds_read_b64_tr_b16 v[30:31], v6 offset:63296
  v_cvt_pk_bf16_f32 v149, v58, v59
  v_mul_f32 v60, v0, v60
  v_mul_f32 v61, v0, v61
  s_waitcnt lgkmcnt(5)
  v_mfma_f32_32x32x16_bf16 v[64:79], v[16:19], v[248:251], v[64:79]
  ds_read_b64_tr_b16 v[8:9], v6 offset:16512
  ds_read_b64_tr_b16 v[10:11], v6 offset:17280
  v_mul_f32 v60, v44, v60
  v_mul_f32 v61, v45, v61
  v_cvt_pk_bf16_f32 v150, v60, v61
  v_mul_f32 v62, v0, v62
  v_mfma_f32_32x32x16_bf16 v[80:95], v[20:23], v[248:251], v[80:95]
  ds_read_b64_tr_b16 v[12:13], v6 offset:28800
  ds_read_b64_tr_b16 v[14:15], v6 offset:29568
  v_mul_f32 v63, v0, v63
  v_mul_f32 v62, v46, v62
  v_mul_f32 v63, v47, v63
  s_waitcnt lgkmcnt(4)
  v_mfma_f32_32x32x16_bf16 v[64:79], v[24:27], v[252:255], v[64:79]
  ds_read_b64_tr_b16 v[16:17], v6 offset:19584
  ds_read_b64_tr_b16 v[18:19], v6 offset:20352
  v_cvt_pk_bf16_f32 v151, v62, v63
  buffer_store_dwordx4 v[148:151], v138, s[68:71], s16 offen offset:1024 sc1
  v_mfma_f32_32x32x16_bf16 v[80:95], v[28:31], v[252:255], v[80:95]
  ds_read_b64_tr_b16 v[20:21], v6 offset:31872
  ds_read_b64_tr_b16 v[22:23], v6 offset:32640
  s_waitcnt lgkmcnt(4)
  v_mfma_f32_32x32x16_bf16 v[96:111], v[8:11], v[224:227], v[96:111]
  ds_read_b64_tr_b16 v[24:25], v6 offset:22656
  ds_read_b64_tr_b16 v[26:27], v6 offset:23424
  v_mfma_f32_32x32x16_bf16 v[112:127], v[12:15], v[224:227], v[112:127]
  ds_read_b64_tr_b16 v[28:29], v6 offset:34944
  ds_read_b64_tr_b16 v[30:31], v6 offset:35712
  s_waitcnt lgkmcnt(4)
  v_mfma_f32_32x32x16_bf16 v[96:111], v[16:19], v[228:231], v[96:111]
  ds_read_b64_tr_b16 v[8:9], v6 offset:25728
  ds_read_b64_tr_b16 v[10:11], v6 offset:26496
  v_mul_f32 v80, v0, v80
  v_mul_f32 v81, v0, v81
  v_mul_f32 v80, v64, v80
  v_mul_f32 v81, v65, v81
  v_mfma_f32_32x32x16_bf16 v[112:127], v[20:23], v[228:231], v[112:127]
  ds_read_b64_tr_b16 v[12:13], v6 offset:38016
  ds_read_b64_tr_b16 v[14:15], v6 offset:38784
  v_cvt_pk_bf16_f32 v152, v80, v81
  v_mul_f32 v82, v0, v82
  v_mul_f32 v83, v0, v83
  s_waitcnt lgkmcnt(4)
  v_mfma_f32_32x32x16_bf16 v[96:111], v[24:27], v[232:235], v[96:111]
  ds_read_b64_tr_b16 v[16:17], v6 offset:41088
  ds_read_b64_tr_b16 v[18:19], v6 offset:41856
  v_mul_f32 v82, v66, v82
  v_mul_f32 v83, v67, v83
  v_cvt_pk_bf16_f32 v153, v82, v83
  v_mul_f32 v84, v0, v84
  v_mfma_f32_32x32x16_bf16 v[112:127], v[28:31], v[232:235], v[112:127]
  ds_read_b64_tr_b16 v[20:21], v6 offset:53376
  ds_read_b64_tr_b16 v[22:23], v6 offset:54144
  v_mul_f32 v85, v0, v85
  v_mul_f32 v84, v68, v84
  v_mul_f32 v85, v69, v85
  s_waitcnt lgkmcnt(4)
  v_mfma_f32_32x32x16_bf16 v[96:111], v[8:11], v[236:239], v[96:111]
  ds_read_b64_tr_b16 v[24:25], v6 offset:44160
  ds_read_b64_tr_b16 v[26:27], v6 offset:44928
  v_cvt_pk_bf16_f32 v154, v84, v85
  v_mul_f32 v86, v0, v86
  v_mul_f32 v87, v0, v87
  v_mul_f32 v86, v70, v86
  v_mfma_f32_32x32x16_bf16 v[112:127], v[12:15], v[236:239], v[112:127]
  ds_read_b64_tr_b16 v[28:29], v6 offset:56448
  ds_read_b64_tr_b16 v[30:31], v6 offset:57216
  v_mul_f32 v87, v71, v87
  v_cvt_pk_bf16_f32 v155, v86, v87
  buffer_store_dwordx4 v[152:155], v138, s[68:71], s17 offen offset:0 sc1
  s_waitcnt lgkmcnt(4)
  v_mfma_f32_32x32x16_bf16 v[96:111], v[16:19], v[240:243], v[96:111]
  ds_read_b64_tr_b16 v[8:9], v6 offset:47232
  ds_read_b64_tr_b16 v[10:11], v6 offset:48000
  v_mul_f32 v88, v0, v88
  v_mul_f32 v89, v0, v89
  v_mul_f32 v88, v72, v88
  v_mul_f32 v89, v73, v89
  v_mfma_f32_32x32x16_bf16 v[112:127], v[20:23], v[240:243], v[112:127]
  ds_read_b64_tr_b16 v[12:13], v6 offset:59520
  ds_read_b64_tr_b16 v[14:15], v6 offset:60288
  v_cvt_pk_bf16_f32 v156, v88, v89
  v_mul_f32 v90, v0, v90
  v_mul_f32 v91, v0, v91
  s_waitcnt lgkmcnt(4)
  v_mfma_f32_32x32x16_bf16 v[96:111], v[24:27], v[244:247], v[96:111]
  ds_read_b64_tr_b16 v[16:17], v6 offset:50304
  ds_read_b64_tr_b16 v[18:19], v6 offset:51072
  v_mul_f32 v90, v74, v90
  v_mul_f32 v91, v75, v91
  v_cvt_pk_bf16_f32 v157, v90, v91
  v_mul_f32 v92, v0, v92
  v_mfma_f32_32x32x16_bf16 v[112:127], v[28:31], v[244:247], v[112:127]
  ds_read_b64_tr_b16 v[20:21], v6 offset:62592
  ds_read_b64_tr_b16 v[22:23], v6 offset:63360
  v_mul_f32 v93, v0, v93
  v_mul_f32 v92, v76, v92
  v_mul_f32 v93, v77, v93
  s_waitcnt lgkmcnt(4)
  v_mfma_f32_32x32x16_bf16 v[96:111], v[8:11], v[248:251], v[96:111]
  v_cvt_pk_bf16_f32 v158, v92, v93
  v_mul_f32 v94, v0, v94
  v_mul_f32 v95, v0, v95
  v_mul_f32 v94, v78, v94
  v_mul_f32 v95, v79, v95
  v_cvt_pk_bf16_f32 v159, v94, v95
  v_mfma_f32_32x32x16_bf16 v[112:127], v[12:15], v[248:251], v[112:127]
  buffer_store_dwordx4 v[156:159], v138, s[68:71], s17 offen offset:1024 sc1
  s_waitcnt lgkmcnt(0)
  v_mfma_f32_32x32x16_bf16 v[96:111], v[16:19], v[252:255], v[96:111]
  v_mfma_f32_32x32x16_bf16 v[112:127], v[20:23], v[252:255], v[112:127]
  v_mov_b32 v4, 13
  ds_write_b32 v5, v4 offset:0
  s_nop 9
  v_mul_f32 v112, v0, v112
  v_mul_f32 v113, v0, v113
  v_mul_f32 v112, v96, v112
  v_mul_f32 v113, v97, v113
  v_cvt_pk_bf16_f32 v160, v112, v113
  v_mul_f32 v114, v0, v114
  v_mul_f32 v115, v0, v115
  v_mul_f32 v114, v98, v114
  v_mul_f32 v115, v99, v115
  v_cvt_pk_bf16_f32 v161, v114, v115
  v_mul_f32 v116, v0, v116
  v_mul_f32 v117, v0, v117
  v_mul_f32 v116, v100, v116
  v_mul_f32 v117, v101, v117
  v_cvt_pk_bf16_f32 v162, v116, v117
  v_mul_f32 v118, v0, v118
  v_mul_f32 v119, v0, v119
  v_mul_f32 v118, v102, v118
  v_mul_f32 v119, v103, v119
  v_cvt_pk_bf16_f32 v163, v118, v119
  buffer_store_dwordx4 v[160:163], v138, s[68:71], s18 offen offset:0 sc1
  v_mul_f32 v120, v0, v120
  v_mul_f32 v121, v0, v121
  v_mul_f32 v120, v104, v120
  v_mul_f32 v121, v105, v121
  v_cvt_pk_bf16_f32 v164, v120, v121
  v_mul_f32 v122, v0, v122
  v_mul_f32 v123, v0, v123
  v_mul_f32 v122, v106, v122
  v_mul_f32 v123, v107, v123
  v_cvt_pk_bf16_f32 v165, v122, v123
  v_mul_f32 v124, v0, v124
  v_mul_f32 v125, v0, v125
  v_mul_f32 v124, v108, v124
  v_mul_f32 v125, v109, v125
  v_cvt_pk_bf16_f32 v166, v124, v125
  v_mul_f32 v126, v0, v126
  v_mul_f32 v127, v0, v127
  v_mul_f32 v126, v110, v126
  v_mul_f32 v127, v111, v127
  v_cvt_pk_bf16_f32 v167, v126, v127
  buffer_store_dwordx4 v[164:167], v138, s[68:71], s18 offen offset:1024 sc1
  v_mov_b32 v106, v2
  v_mov_b32 v107, v5
L_spin13:
  ds_read_b32 v104, v106 offset:16
  s_sub_u32 s99, s99, 1
  s_cbranch_scc1 L_end
  s_waitcnt lgkmcnt(0)
  v_cmp_gt_u32 vcc, 10, v104
  s_cbranch_vccnz L_spin13
  s_add_u32 s100, s95, 1
  s_and_b32 s100, s100, 3
  s_lshl2_add_u32 s100, s7, s100
  s_lshl_b32 s100, s100, 13
  buffer_load_dwordx4 v[172:175], v7, s[68:71], s100 offen sc1
  buffer_load_dwordx4 v[176:179], v139, s[68:71], s100 offen sc1
  buffer_load_dwordx4 v[180:183], v7, s[68:71], s100 offen offset:1024 sc1
  buffer_load_dwordx4 v[184:187], v139, s[68:71], s100 offen offset:1024 sc1
  buffer_load_dwordx4 v[188:191], v7, s[68:71], s100 offen offset:2048 sc1
  buffer_load_dwordx4 v[192:195], v139, s[68:71], s100 offen offset:2048 sc1
  s_and_b32 s10, s3, 1
  s_lshr_b32 s11, s3, 1
  v_lshrrev_b32 v141, 5, v1
  v_and_b32 v143, 31, v1
  s_lshl1_add_u32 s12, s6, s10
  s_lshl_b32 s12, s12, 7
  s_lshl1_add_u32 s9, s7, s11
  s_lshl2_add_u32 s13, s4, s9
  s_lshl_b32 s13, s13, 16
  s_add_u32 s13, s13, s12
  v_lshlrev_b32 v142, 15, v141
  v_lshl_add_u32 v142, v143, 2, v142
  v_add_u32 v132, s13, v142
  s_lshl_b32 s9, s9, 7
  s_add_u32 s9, s9, 147456
  v_lshl_add_u32 v131, v141, 6, s9
  s_lshl_b32 s9, s10, 6
  s_lshl_b32 s12, s11, 12
  s_add_u32 s12, s12, s9
  s_add_u32 s12, s12, 152576
  v_lshlrev_b32 v142, 11, v141
  v_lshl_add_u32 v142, v143, 1, v142
  v_add_u32 v130, s12, v142
  s_lshl_b32 s12, s3, 12
  s_add_u32 s12, s12, 65536
  v_lshl_add_u32 v128, v1, 4, s12
  v_bfe_u32 v142, v1, 2, 2
  v_lshl_add_u32 v142, v141, 3, v142
  v_lshlrev_b32 v142, 7, v142
  v_and_b32 v6, 16, v1
  v_lshl_add_u32 v142, v6, 1, v142
  v_and_b32 v6, 3, v1
  v_lshl_add_u32 v142, v6, 3, v142
  v_and_b32 v6, 8, v1
  v_lshlrev_b32 v6, 3, v6
  v_xor_b32 v6, s9, v6
  s_lshl_b32 s12, s10, 13
  v_add3_u32 v129, v142, v6, s12
  v_xor_b32 v133, 64, v129
  s_mul_i32 s9, s10, 12288
  v_bfe_u32 v142, v143, 1, 3
  v_xor_b32 v142, v142, v141
  v_lshlrev_b32 v142, 4, v142
  v_lshl_add_u32 v142, v143, 7, v142
  v_add_u32 v134, s9, v142
  v_xor_b32 v135, 32, v134
  v_xor_b32 v136, 64, v134
  v_xor_b32 v137, 96, v134
  v_xor_b32 v2, 4096, v134
  v_xor_b32 v3, 4096, v135
  v_xor_b32 v4, 4096, v136
  v_xor_b32 v5, 4096, v137
  s_waitcnt vmcnt(8)
  v_mov_b32 v105, 14
  ds_write_b32 v107, v105 offset:0
  buffer_load_dwordx4 v[196:199], v7, s[68:71], s100 offen offset:3072 sc1
  buffer_load_dwordx4 v[200:203], v139, s[68:71], s100 offen offset:3072 sc1
  s_add_u32 s100, s95, 2
  s_and_b32 s100, s100, 3
  s_lshl2_add_u32 s100, s7, s100
  s_lshl_b32 s100, s100, 13
  buffer_load_dwordx4 v[204:207], v7, s[68:71], s100 offen sc1
  buffer_load_dwordx4 v[208:211], v139, s[68:71], s100 offen sc1
  buffer_load_dwordx4 v[212:215], v7, s[68:71], s100 offen offset:1024 sc1
  buffer_load_dwordx4 v[216:219], v139, s[68:71], s100 offen offset:1024 sc1
  buffer_load_dwordx4 v[220:223], v7, s[68:71], s100 offen offset:2048 sc1
  buffer_load_dwordx4 v[224:227], v139, s[68:71], s100 offen offset:2048 sc1
  buffer_load_dwordx4 v[228:231], v7, s[68:71], s100 offen offset:3072 sc1
  buffer_load_dwordx4 v[232:235], v139, s[68:71], s100 offen offset:3072 sc1
  s_barrier
  ds_read_b128 v[8:11], v134 offset:49152
  ds_read_b128 v[12:15], v2 offset:49152
  ds_read_b128 v[16:19], v135 offset:49152
  s_waitcnt vmcnt(15) lgkmcnt(2)
  v_mfma_f32_32x32x16_bf16 v[64:79], v[172:175], v[8:11], 0
  v_mov_b32 v105, 15
  ds_write_b32 v107, v105 offset:0
  ds_read_b128 v[20:23], v3 offset:49152
  s_lshl4_add_u32 s9, s4, s5
  s_lshl2_add_u32 s9, s9, s3
  s_lshl_b32 s9, s9, 12
  s_add_u32 s20, s9, 16777216
  s_xor_b32 s21, s20, 131072
  s_waitcnt vmcnt(14)
  v_mfma_f32_32x32x16_bf16 v[32:47], v[176:179], v[8:11], 0
  s_mov_b32 s16, 0x07060500
  s_mov_b32 s17, 0x07060501
  s_mov_b32 s18, 0x07060502
  s_mov_b32 s22, 0x07060503
  s_mov_b32 s23, 0x0c0c0400
  s_mov_b32 s53, 0x05040100
  v_lshlrev_b32 v0, 4, v1
  s_waitcnt lgkmcnt(3)
  v_mfma_f32_32x32x16_bf16 v[80:95], v[172:175], v[12:15], 0
  s_add_u32 s100, s95, 3
  s_and_b32 s100, s100, 3
  s_lshl2_add_u32 s100, s7, s100
  s_lshl_b32 s100, s100, 13
  buffer_load_dwordx4 v[236:239], v7, s[68:71], s100 offen sc1
  ds_read_b128 v[24:27], v136 offset:49152
  v_mov_b32 v144, 0
  v_mov_b32 v145, 0
  v_mfma_f32_32x32x16_bf16 v[48:63], v[176:179], v[12:15], 0
  buffer_load_dwordx4 v[240:243], v139, s[68:71], s100 offen sc1
  v_mov_b32 v146, 0
  v_mov_b32 v147, 0
  v_mov_b32 v148, 0
  v_mov_b32 v149, 0
  v_mov_b32 v150, 0
  v_mov_b32 v151, 0
  s_waitcnt vmcnt(15) lgkmcnt(3)
  v_mfma_f32_32x32x16_bf16 v[64:79], v[180:183], v[16:19], v[64:79]
  ds_read_b128 v[28:31], v4 offset:49152
  v_mov_b32 v152, 0
  v_mov_b32 v153, 0
  v_mov_b32 v154, 0
  v_mov_b32 v155, 0
  v_mov_b32 v156, 0
  v_mov_b32 v157, 0
  v_mov_b32 v158, 0
  s_waitcnt vmcnt(14)
  v_mfma_f32_32x32x16_bf16 v[32:47], v[184:187], v[16:19], v[32:47]
  v_mov_b32 v159, 0
  ds_read_u16_d16_hi v144, v130 offset:0
  ds_read_u16_d16_hi v145, v130 offset:128
  ds_read_u16_d16_hi v146, v130 offset:256
  ds_read_u16_d16_hi v147, v130 offset:384
  ds_read_u16_d16_hi v148, v130 offset:512
  ds_read_u16_d16_hi v149, v130 offset:640
  s_waitcnt lgkmcnt(8)
  v_mfma_f32_32x32x16_bf16 v[80:95], v[180:183], v[20:23], v[80:95]
  buffer_load_dwordx4 v[244:247], v7, s[68:71], s100 offen offset:1024 sc1
  ds_read_b128 v[96:99], v137 offset:49152
  ds_read_u16_d16_hi v150, v130 offset:768
  ds_read_u16_d16_hi v151, v130 offset:896
  ds_read_u16_d16_hi v152, v130 offset:1024
  ds_read_u16_d16_hi v153, v130 offset:1152
  ds_read_u16_d16_hi v154, v130 offset:1280
  ds_read_u16_d16_hi v155, v130 offset:1408
  v_mfma_f32_32x32x16_bf16 v[48:63], v[184:187], v[20:23], v[48:63]
  buffer_load_dwordx4 v[248:251], v139, s[68:71], s100 offen offset:1024 sc1
  ds_read_u16_d16_hi v156, v130 offset:1536
  ds_read_u16_d16_hi v157, v130 offset:1664
  ds_read_u16_d16_hi v158, v130 offset:1792
  ds_read_u16_d16_hi v159, v130 offset:1920
  ds_read_b128 v[160:163], v131 offset:0
  ds_read_b128 v[164:167], v131 offset:512
  s_waitcnt vmcnt(15) lgkmcnt(15)
  v_mfma_f32_32x32x16_bf16 v[64:79], v[188:191], v[24:27], v[64:79]
  ds_read_b128 v[100:103], v5 offset:49152
  s_waitcnt vmcnt(14)
  v_mfma_f32_32x32x16_bf16 v[32:47], v[192:195], v[24:27], v[32:47]
  v_mfma_f32_32x32x16_bf16 v[80:95], v[188:191], v[28:31], v[80:95]
  buffer_load_dwordx4 v[252:255], v7, s[68:71], s100 offen offset:2048 sc1
  v_add_u32 v134, 49152, v134
  v_add_u32 v135, 49152, v135
  v_add_u32 v136, 49152, v136
  v_add_u32 v137, 49152, v137
  v_add_u32 v2, 49152, v2
  v_add_u32 v3, 49152, v3
  v_add_u32 v4, 49152, v4
  v_add_u32 v5, 49152, v5
  ds_read_b128 v[8:11], v134 offset:16384
  v_mfma_f32_32x32x16_bf16 v[48:63], v[192:195], v[28:31], v[48:63]
  buffer_load_dwordx4 v[108:111], v139, s[68:71], s100 offen offset:2048 sc1
  s_waitcnt lgkmcnt(2)
  v_sub_f32 v168, v144, v164
  v_sub_f32 v169, v145, v165
  v_cvt_pk_bf16_f32 v170, v168, v169
  v_lshlrev_b32 v168, 16, v170
  v_and_b32 v169, 0xffff0000, v170
  s_waitcnt vmcnt(15)
  v_mfma_f32_32x32x16_bf16 v[64:79], v[196:199], v[96:99], v[64:79]
  ds_read_b128 v[12:15], v2 offset:16384
  v_mul_f32 v168, v168, v160
  v_mul_f32 v169, v169, v161
  v_cvt_pk_bf16_f32 v170, v168, v169
  v_lshlrev_b32 v168, 16, v170
  v_and_b32 v169, 0xffff0000, v170
  v_mul_f32 v168, v168, v140
  v_mul_f32 v169, v169, v140
  s_waitcnt vmcnt(14)
  v_mfma_f32_32x32x16_bf16 v[32:47], v[200:203], v[96:99], v[32:47]
  v_cvt_pk_bf16_f32 v170, v168, v169
  v_lshlrev_b32 v168, 16, v170
  v_and_b32 v169, 0xffff0000, v170
  v_add_f32 v144, v144, v168
  v_add_f32 v145, v145, v169
  v_sub_f32 v168, v146, v166
  v_sub_f32 v169, v147, v167
  s_waitcnt lgkmcnt(2)
  v_mfma_f32_32x32x16_bf16 v[80:95], v[196:199], v[100:103], v[80:95]
  buffer_load_dwordx4 v[112:115], v7, s[68:71], s100 offen offset:3072 sc1
  ds_read_b128 v[16:19], v135 offset:16384
  v_cvt_pk_bf16_f32 v170, v168, v169
  v_lshlrev_b32 v168, 16, v170
  v_and_b32 v169, 0xffff0000, v170
  v_mul_f32 v168, v168, v162
  v_mul_f32 v169, v169, v163
  v_cvt_pk_bf16_f32 v170, v168, v169
  v_mfma_f32_32x32x16_bf16 v[48:63], v[200:203], v[100:103], v[48:63]
  buffer_load_dwordx4 v[116:119], v139, s[68:71], s100 offen offset:3072 sc1
  v_lshlrev_b32 v168, 16, v170
  v_and_b32 v169, 0xffff0000, v170
  v_mul_f32 v168, v168, v140
  v_mul_f32 v169, v169, v140
  v_cvt_pk_bf16_f32 v170, v168, v169
  v_lshlrev_b32 v168, 16, v170
  s_waitcnt vmcnt(15) lgkmcnt(2)
  v_mfma_f32_32x32x16_bf16 v[64:79], v[204:207], v[8:11], v[64:79]
  ds_read_b128 v[20:23], v3 offset:16384
  v_and_b32 v169, 0xffff0000, v170
  v_add_f32 v146, v146, v168
  v_add_f32 v147, v147, v169
  ds_read_b128 v[160:163], v131 offset:16
  ds_read_b128 v[164:167], v131 offset:528
  s_waitcnt vmcnt(14)
  v_mfma_f32_32x32x16_bf16 v[32:47], v[208:211], v[8:11], v[32:47]
  s_waitcnt lgkmcnt(4)
  v_mfma_f32_32x32x16_bf16 v[80:95], v[204:207], v[12:15], v[80:95]
  s_add_u32 s100, s95, 0
  s_and_b32 s100, s100, 3
  s_lshl2_add_u32 s100, s7, s100
  s_lshl_b32 s100, s100, 13
  buffer_load_dwordx4 v[120:123], v7, s[68:71], s100 offen sc1
  ds_read_b128 v[24:27], v136 offset:16384
  v_mfma_f32_32x32x16_bf16 v[48:63], v[208:211], v[12:15], v[48:63]
  buffer_load_dwordx4 v[124:127], v7, s[68:71], s100 offen offset:1024 sc1
  s_waitcnt lgkmcnt(1)
  v_sub_f32 v168, v148, v164
  v_sub_f32 v169, v149, v165
  v_cvt_pk_bf16_f32 v170, v168, v169
  v_lshlrev_b32 v168, 16, v170
  v_and_b32 v169, 0xffff0000, v170
  s_waitcnt vmcnt(15)
  v_mfma_f32_32x32x16_bf16 v[64:79], v[212:215], v[16:19], v[64:79]
  ds_read_b128 v[28:31], v4 offset:16384
  v_mul_f32 v168, v168, v160
  v_mul_f32 v169, v169, v161
  v_cvt_pk_bf16_f32 v170, v168, v169
  v_lshlrev_b32 v168, 16, v170
  v_and_b32 v169, 0xffff0000, v170
  v_mul_f32 v168, v168, v140
  v_mul_f32 v169, v169, v140
  s_waitcnt vmcnt(14)
  v_mfma_f32_32x32x16_bf16 v[32:47], v[216:219], v[16:19], v[32:47]
  v_cvt_pk_bf16_f32 v170, v168, v169
  v_lshlrev_b32 v168, 16, v170
  v_and_b32 v169, 0xffff0000, v170
  v_add_f32 v148, v148, v168
  v_add_f32 v149, v149, v169
  v_sub_f32 v168, v150, v166
  v_sub_f32 v169, v151, v167
  v_mfma_f32_32x32x16_bf16 v[80:95], v[212:215], v[20:23], v[80:95]
  buffer_load_dwordx4 v[172:175], v7, s[68:71], s100 offen offset:2048 sc1
  ds_read_b32 v104, v106 offset:16
  ds_read_b128 v[96:99], v137 offset:16384
  v_cvt_pk_bf16_f32 v170, v168, v169
  v_lshlrev_b32 v168, 16, v170
  v_and_b32 v169, 0xffff0000, v170
  v_mul_f32 v168, v168, v162
  v_mul_f32 v169, v169, v163
  v_mfma_f32_32x32x16_bf16 v[48:63], v[216:219], v[20:23], v[48:63]
  buffer_load_dwordx4 v[176:179], v7, s[68:71], s100 offen offset:3072 sc1
  v_cvt_pk_bf16_f32 v170, v168, v169
  v_lshlrev_b32 v168, 16, v170
  v_and_b32 v169, 0xffff0000, v170
  v_mul_f32 v168, v168, v140
  v_mul_f32 v169, v169, v140
  v_cvt_pk_bf16_f32 v170, v168, v169
  s_waitcnt vmcnt(15) lgkmcnt(3)
  v_mfma_f32_32x32x16_bf16 v[64:79], v[220:223], v[24:27], v[64:79]
  ds_read_b128 v[100:103], v5 offset:16384
  v_lshlrev_b32 v168, 16, v170
  v_and_b32 v169, 0xffff0000, v170
  v_add_f32 v150, v150, v168
  v_add_f32 v151, v151, v169
  ds_read_b128 v[160:163], v131 offset:32
  ds_read_b128 v[164:167], v131 offset:544
  s_waitcnt vmcnt(14)
  v_mfma_f32_32x32x16_bf16 v[32:47], v[224:227], v[24:27], v[32:47]
  s_waitcnt lgkmcnt(5)
  v_mfma_f32_32x32x16_bf16 v[80:95], v[220:223], v[28:31], v[80:95]
  s_waitcnt lgkmcnt(4)
  v_cmp_gt_u32 vcc, 11, v104
  s_cbranch_vccnz L_slow_chk14
L_back_chk14:
  s_add_u32 s100, s95, 1
  s_and_b32 s100, s100, 3
  s_bitcmp1_b32 s54, s100
  s_cselect_b32 s55, 0x40000000, 0
  s_lshl_b32 s100, s100, 13
  s_add_u32 s100, s100, s52
  s_add_u32 s55, s55, s100
  buffer_load_dwordx4 v[180:183], v7, s[68:71], s100 offen sc1
  ds_read_b128 v[8:11], v134 offset:32768
  v_mfma_f32_32x32x16_bf16 v[48:63], v[224:227], v[28:31], v[48:63]
  buffer_load_dwordx4 v[184:187], v7, s[68:71], s100 offen offset:1024 sc1
  s_waitcnt lgkmcnt(1)
  v_sub_f32 v168, v152, v164
  v_sub_f32 v169, v153, v165
  v_cvt_pk_bf16_f32 v170, v168, v169
  v_lshlrev_b32 v168, 16, v170
  v_and_b32 v169, 0xffff0000, v170
  s_waitcnt vmcnt(15)
  v_mfma_f32_32x32x16_bf16 v[64:79], v[228:231], v[96:99], v[64:79]
  ds_read_b128 v[12:15], v2 offset:32768
  v_mul_f32 v168, v168, v160
  v_mul_f32 v169, v169, v161
  v_cvt_pk_bf16_f32 v170, v168, v169
  v_lshlrev_b32 v168, 16, v170
  v_and_b32 v169, 0xffff0000, v170
  v_mul_f32 v168, v168, v140
  v_mul_f32 v169, v169, v140
  s_waitcnt vmcnt(14)
  v_mfma_f32_32x32x16_bf16 v[32:47], v[232:235], v[96:99], v[32:47]
  v_cvt_pk_bf16_f32 v170, v168, v169
  v_lshlrev_b32 v168, 16, v170
  v_and_b32 v169, 0xffff0000, v170
  v_add_f32 v152, v152, v168
  v_add_f32 v153, v153, v169
  v_sub_f32 v168, v154, v166
  v_sub_f32 v169, v155, v167
  v_mfma_f32_32x32x16_bf16 v[80:95], v[228:231], v[100:103], v[80:95]
  buffer_load_dwordx4 v[188:191], v7, s[68:71], s55 offen offset:2048 sc1
  ds_read_b128 v[16:19], v135 offset:32768
  v_cvt_pk_bf16_f32 v170, v168, v169
  v_lshlrev_b32 v168, 16, v170
  v_and_b32 v169, 0xffff0000, v170
  v_mul_f32 v168, v168, v162
  v_mul_f32 v169, v169, v163
  v_cvt_pk_bf16_f32 v170, v168, v169
  v_mfma_f32_32x32x16_bf16 v[48:63], v[232:235], v[100:103], v[48:63]
  buffer_load_dwordx4 v[192:195], v7, s[68:71], s55 offen offset:3072 sc1
  v_lshlrev_b32 v168, 16, v170
  v_and_b32 v169, 0xffff0000, v170
  v_mul_f32 v168, v168, v140
  v_mul_f32 v169, v169, v140
  v_cvt_pk_bf16_f32 v170, v168, v169
  v_lshlrev_b32 v168, 16, v170
  s_waitcnt vmcnt(15) lgkmcnt(2)
  v_mfma_f32_32x32x16_bf16 v[64:79], v[236:239], v[8:11], v[64:79]
  ds_read_b128 v[20:23], v3 offset:32768
  v_and_b32 v169, 0xffff0000, v170
  v_add_f32 v154, v154, v168
  v_add_f32 v155, v155, v169
  ds_read_b128 v[160:163], v131 offset:48
  ds_read_b128 v[164:167], v131 offset:560
  s_waitcnt vmcnt(14)
  v_mfma_f32_32x32x16_bf16 v[32:47], v[240:243], v[8:11], v[32:47]
  s_waitcnt lgkmcnt(4)
  v_mfma_f32_32x32x16_bf16 v[80:95], v[236:239], v[12:15], v[80:95]
  s_add_u32 s100, s95, 2
  s_and_b32 s100, s100, 3
  s_bitcmp1_b32 s54, s100
  s_cselect_b32 s55, 0x40000000, 0
  s_lshl_b32 s100, s100, 13
  s_add_u32 s100, s100, s52
  s_add_u32 s55, s55, s100
  buffer_load_dwordx4 v[196:199], v7, s[68:71], s100 offen sc1
  ds_read_b128 v[24:27], v136 offset:32768
  v_mfma_f32_32x32x16_bf16 v[48:63], v[240:243], v[12:15], v[48:63]
  buffer_load_dwordx4 v[200:203], v7, s[68:71], s100 offen offset:1024 sc1
  s_waitcnt lgkmcnt(1)
  v_sub_f32 v168, v156, v164
  v_sub_f32 v169, v157, v165
  v_cvt_pk_bf16_f32 v170, v168, v169
  v_lshlrev_b32 v168, 16, v170
  v_and_b32 v169, 0xffff0000, v170
  s_waitcnt vmcnt(15)
  v_mfma_f32_32x32x16_bf16 v[64:79], v[244:247], v[16:19], v[64:79]
  ds_read_b128 v[28:31], v4 offset:32768
  v_mul_f32 v168, v168, v160
  v_mul_f32 v169, v169, v161
  v_cvt_pk_bf16_f32 v170, v168, v169
  v_lshlrev_b32 v168, 16, v170
  v_and_b32 v169, 0xffff0000, v170
  v_mul_f32 v168, v168, v140
  v_mul_f32 v169, v169, v140
  s_waitcnt vmcnt(14)
  v_mfma_f32_32x32x16_bf16 v[32:47], v[248:251], v[16:19], v[32:47]
  v_cvt_pk_bf16_f32 v170, v168, v169
  v_lshlrev_b32 v168, 16, v170
  v_and_b32 v169, 0xffff0000, v170
  v_add_f32 v156, v156, v168
  v_add_f32 v157, v157, v169
  v_sub_f32 v168, v158, v166
  v_sub_f32 v169, v159, v167
  v_mfma_f32_32x32x16_bf16 v[80:95], v[244:247], v[20:23], v[80:95]
  buffer_load_dwordx4 v[204:207], v7, s[68:71], s55 offen offset:2048 sc1
  ds_read_b128 v[96:99], v137 offset:32768
  v_cvt_pk_bf16_f32 v170, v168, v169
  v_lshlrev_b32 v168, 16, v170
  v_and_b32 v169, 0xffff0000, v170
  v_mul_f32 v168, v168, v162
  v_mul_f32 v169, v169, v163
  v_cvt_pk_bf16_f32 v170, v168, v169
  v_mfma_f32_32x32x16_bf16 v[48:63], v[248:251], v[20:23], v[48:63]
  buffer_load_dwordx4 v[208:211], v7, s[68:71], s55 offen offset:3072 sc1
  v_lshlrev_b32 v168, 16, v170
  v_and_b32 v169, 0xffff0000, v170
  v_mul_f32 v168, v168, v140
  v_mul_f32 v169, v169, v140
  v_cvt_pk_bf16_f32 v170, v168, v169
  v_lshlrev_b32 v168, 16, v170
  s_waitcnt vmcnt(15) lgkmcnt(2)
  v_mfma_f32_32x32x16_bf16 v[64:79], v[252:255], v[24:27], v[64:79]
  ds_read_b128 v[100:103], v5 offset:32768
  v_and_b32 v169, 0xffff0000, v170
  v_add_f32 v158, v158, v168
  v_add_f32 v159, v159, v169
  s_waitcnt vmcnt(14)
  v_mfma_f32_32x32x16_bf16 v[32:47], v[108:111], v[24:27], v[32:47]
  s_waitcnt lgkmcnt(2)
  v_mfma_f32_32x32x16_bf16 v[80:95], v[252:255], v[28:31], v[80:95]
  s_add_u32 s100, s95, 3
  s_and_b32 s100, s100, 3
  s_bitcmp1_b32 s54, s100
  s_cselect_b32 s55, 0x40000000, 0
  s_lshl_b32 s100, s100, 13
  s_add_u32 s100, s100, s52
  s_add_u32 s55, s55, s100
  buffer_load_dwordx4 v[212:215], v7, s[68:71], s100 offen sc1
  ds_read_b128 v[8:11], v134 offset:49152
  v_mfma_f32_32x32x16_bf16 v[48:63], v[108:111], v[28:31], v[48:63]
  buffer_load_dwordx4 v[216:219], v7, s[68:71], s100 offen offset:1024 sc1
  ds_read_b128 v[12:15], v2 offset:49152
  s_waitcnt vmcnt(15) lgkmcnt(3)
  v_mfma_f32_32x32x16_bf16 v[64:79], v[112:115], v[96:99], v[64:79]
  ds_read_b128 v[16:19], v135 offset:49152
  s_waitcnt vmcnt(14)
  v_mfma_f32_32x32x16_bf16 v[32:47], v[116:119], v[96:99], v[32:47]
  ds_read_b128 v[20:23], v3 offset:49152
  s_waitcnt lgkmcnt(4)
  v_mfma_f32_32x32x16_bf16 v[80:95], v[112:115], v[100:103], v[80:95]
  buffer_load_dwordx4 v[220:223], v7, s[68:71], s55 offen offset:2048 sc1
  ds_read_b128 v[24:27], v136 offset:49152
  v_mfma_f32_32x32x16_bf16 v[48:63], v[116:119], v[100:103], v[48:63]
  buffer_load_dwordx4 v[224:227], v7, s[68:71], s55 offen offset:3072 sc1
  ds_read_b128 v[28:31], v4 offset:49152
  s_waitcnt vmcnt(15) lgkmcnt(4)
  v_mfma_f32_32x32x16_bf16 v[64:79], v[120:123], v[8:11], v[64:79]
  ds_read_b128 v[96:99], v137 offset:49152
  v_mfma_f32_32x32x16_bf16 v[80:95], v[120:123], v[12:15], v[80:95]
  s_add_u32 s100, s95, 0
  s_and_b32 s100, s100, 3
  s_bitcmp1_b32 s54, s100
  s_cselect_b32 s55, 0x40000000, 0
  s_lshl_b32 s100, s100, 13
  s_add_u32 s100, s100, s52
  s_add_u32 s55, s55, s100
  buffer_load_dwordx4 v[228:231], v7, s[68:71], s100 offen sc1
  ds_read_b128 v[100:103], v5 offset:49152
  s_waitcnt vmcnt(15) lgkmcnt(4)
  v_mfma_f32_32x32x16_bf16 v[64:79], v[124:127], v[16:19], v[64:79]
  ds_read_b64_tr_b16 v[8:9], v129 offset:0
  ds_read_b64_tr_b16 v[10:11], v129 offset:512
  v_mfma_f32_32x32x16_bf16 v[80:95], v[124:127], v[20:23], v[80:95]
  buffer_load_dwordx4 v[232:235], v7, s[68:71], s100 offen offset:1024 sc1
  ds_read_b64_tr_b16 v[12:13], v133 offset:0
  ds_read_b64_tr_b16 v[14:15], v133 offset:512
  s_waitcnt vmcnt(15) lgkmcnt(6)
  v_mfma_f32_32x32x16_bf16 v[64:79], v[172:175], v[24:27], v[64:79]
  ds_read_b64_tr_b16 v[16:17], v129 offset:2048
  ds_read_b64_tr_b16 v[18:19], v129 offset:2560
  v_mfma_f32_32x32x16_bf16 v[80:95], v[172:175], v[28:31], v[80:95]
  buffer_load_dwordx4 v[236:239], v7, s[68:71], s55 offen offset:2048 sc1
  ds_read_b64_tr_b16 v[20:21], v133 offset:2048
  ds_read_b64_tr_b16 v[22:23], v133 offset:2560
  s_waitcnt vmcnt(15) lgkmcnt(8)
  v_mfma_f32_32x32x16_bf16 v[64:79], v[176:179], v[96:99], v[64:79]
  ds_read_b64_tr_b16 v[24:25], v129 offset:4096
  ds_read_b64_tr_b16 v[26:27], v129 offset:4608
  v_mfma_f32_32x32x16_bf16 v[80:95], v[176:179], v[100:103], v[80:95]
  buffer_load_dwordx4 v[240:243], v7, s[68:71], s55 offen offset:3072 sc1
  ds_read_b64_tr_b16 v[28:29], v133 offset:4096
  ds_read_b64_tr_b16 v[30:31], v133 offset:4608
  s_waitcnt vmcnt(15) lgkmcnt(8)
  v_mfma_f32_32x32x16_bf16 v[64:79], v[180:183], v[8:11], v[64:79]
  ds_read_b64_tr_b16 v[96:97], v129 offset:6144
  ds_read_b64_tr_b16 v[98:99], v129 offset:6656
  v_mfma_f32_32x32x16_bf16 v[80:95], v[180:183], v[12:15], v[80:95]
  ds_read_b64_tr_b16 v[100:101], v133 offset:6144
  ds_read_b64_tr_b16 v[102:103], v133 offset:6656
  s_waitcnt vmcnt(14) lgkmcnt(8)
  v_mfma_f32_32x32x16_bf16 v[64:79], v[184:187], v[16:19], v[64:79]
  s_barrier
  ds_read_b64_tr_b16 v[8:9], v129 offset:16384
  ds_read_b64_tr_b16 v[10:11], v129 offset:16896
  v_mfma_f32_32x32x16_bf16 v[80:95], v[184:187], v[20:23], v[80:95]
  ds_read_b64_tr_b16 v[12:13], v133 offset:16384
  ds_read_b64_tr_b16 v[14:15], v133 offset:16896
  s_waitcnt vmcnt(13) lgkmcnt(8)
  v_mfma_f32_32x32x16_bf16 v[64:79], v[188:191], v[24:27], v[64:79]
  ds_read_b32 v104, v106 offset:16
  ds_read_b64_tr_b16 v[16:17], v129 offset:18432
  ds_read_b64_tr_b16 v[18:19], v129 offset:18944
  v_mfma_f32_32x32x16_bf16 v[80:95], v[188:191], v[28:31], v[80:95]
  ds_read_b64_tr_b16 v[20:21], v133 offset:18432
  ds_read_b64_tr_b16 v[22:23], v133 offset:18944
  s_waitcnt vmcnt(12) lgkmcnt(9)
  v_mfma_f32_32x32x16_bf16 v[64:79], v[192:195], v[96:99], v[64:79]
  ds_read_b64_tr_b16 v[24:25], v129 offset:20480
  ds_read_b64_tr_b16 v[26:27], v129 offset:20992
  v_mfma_f32_32x32x16_bf16 v[80:95], v[192:195], v[100:103], v[80:95]
  ds_read_b64_tr_b16 v[28:29], v133 offset:20480
  ds_read_b64_tr_b16 v[30:31], v133 offset:20992
  s_waitcnt vmcnt(11) lgkmcnt(9)
  v_mfma_f32_32x32x16_bf16 v[64:79], v[196:199], v[8:11], v[64:79]
  s_waitcnt lgkmcnt(8)
  v_cmp_gt_u32 vcc, 12, v104
  s_cbranch_vccnz L_slow_chk15
L_back_chk15:
  s_add_u32 s100, s95, 4
  s_and_b32 s100, s100, 1
  s_add_u32 s100, s100, 4
  s_bitcmp1_b32 s54, s100
  s_cselect_b32 s55, 0x40000000, 0
  s_lshl_b32 s100, s100, 13
  s_add_u32 s100, s100, s52
  s_add_u32 s55, s55, s100
  buffer_load_dwordx4 v[244:247], v7, s[68:71], s100 offen sc1
  buffer_load_dwordx4 v[248:251], v7, s[68:71], s100 offen offset:1024 sc1
  ds_read_b64_tr_b16 v[96:97], v129 offset:22528
  ds_read_b64_tr_b16 v[98:99], v129 offset:23040
  v_mfma_f32_32x32x16_bf16 v[80:95], v[196:199], v[12:15], v[80:95]
  buffer_load_dwordx4 v[252:255], v7, s[68:71], s55 offen offset:2048 sc1
  ds_read_b64_tr_b16 v[100:101], v133 offset:22528
  ds_read_b64_tr_b16 v[102:103], v133 offset:23040
  s_waitcnt vmcnt(13) lgkmcnt(8)
  v_mfma_f32_32x32x16_bf16 v[64:79], v[200:203], v[16:19], v[64:79]
  buffer_load_dwordx4 v[108:111], v7, s[68:71], s55 offen offset:3072 sc1
  ds_read_b64_tr_b16 v[8:9], v129 offset:32768
  ds_read_b64_tr_b16 v[10:11], v129 offset:33280
  v_mfma_f32_32x32x16_bf16 v[80:95], v[200:203], v[20:23], v[80:95]
  s_add_u32 s100, s95, 5
  s_and_b32 s100, s100, 1
  s_add_u32 s100, s100, 4
  s_bitcmp1_b32 s54, s100
  s_cselect_b32 s55, 0x40000000, 0
  s_lshl_b32 s100, s100, 13
  s_add_u32 s100, s100, s52
  s_add_u32 s55, s55, s100
  buffer_load_dwordx4 v[112:115], v7, s[68:71], s100 offen sc1
  ds_read_b64_tr_b16 v[12:13], v133 offset:32768
  ds_read_b64_tr_b16 v[14:15], v133 offset:33280
  s_waitcnt vmcnt(14) lgkmcnt(8)
  v_mfma_f32_32x32x16_bf16 v[64:79], v[204:207], v[24:27], v[64:79]
  buffer_load_dwordx4 v[116:119], v7, s[68:71], s100 offen offset:1024 sc1
  ds_read_b64_tr_b16 v[16:17], v129 offset:34816
  ds_read_b64_tr_b16 v[18:19], v129 offset:35328
  v_mfma_f32_32x32x16_bf16 v[80:95], v[204:207], v[28:31], v[80:95]
  buffer_load_dwordx4 v[120:123], v7, s[68:71], s55 offen offset:2048 sc1
  ds_read_b64_tr_b16 v[20:21], v133 offset:34816
  ds_read_b64_tr_b16 v[22:23], v133 offset:35328
  s_waitcnt vmcnt(15) lgkmcnt(8)
  v_mfma_f32_32x32x16_bf16 v[64:79], v[208:211], v[96:99], v[64:79]
  ds_read_b64_tr_b16 v[24:25], v129 offset:36864
  ds_read_b64_tr_b16 v[26:27], v129 offset:37376
  v_mfma_f32_32x32x16_bf16 v[80:95], v[208:211], v[100:103], v[80:95]
  buffer_load_dwordx4 v[124:127], v7, s[68:71], s55 offen offset:3072 sc1
  ds_read_b64_tr_b16 v[28:29], v133 offset:36864
  ds_read_b64_tr_b16 v[30:31], v133 offset:37376
  s_waitcnt vmcnt(15) lgkmcnt(8)
  v_mfma_f32_32x32x16_bf16 v[64:79], v[212:215], v[8:11], v[64:79]
  ds_read_b64_tr_b16 v[96:97], v129 offset:38912
  ds_read_b64_tr_b16 v[98:99], v129 offset:39424
  v_mfma_f32_32x32x16_bf16 v[80:95], v[212:215], v[12:15], v[80:95]
  s_add_u32 s100, s95, 1
  s_and_b32 s100, s100, 3
  s_bitcmp1_b32 s54, s100
  s_cselect_b32 s55, 0x40000000, 0
  s_lshl_b32 s100, s100, 13
  s_add_u32 s100, s100, s52
  s_add_u32 s55, s55, s100
  buffer_load_dwordx4 v[172:175], v139, s[68:71], s100 offen sc1
  ds_read_b64_tr_b16 v[100:101], v133 offset:38912
  ds_read_b64_tr_b16 v[102:103], v133 offset:39424
  s_waitcnt vmcnt(15) lgkmcnt(8)
  v_mfma_f32_32x32x16_bf16 v[64:79], v[216:219], v[16:19], v[64:79]
  v_add_u32 v129, 81920, v129
  v_add_u32 v133, 81920, v133
  ds_read_b64_tr_b16 v[8:9], v129 offset:32768
  ds_read_b64_tr_b16 v[10:11], v129 offset:33280
  v_mfma_f32_32x32x16_bf16 v[80:95], v[216:219], v[20:23], v[80:95]
  buffer_load_dwordx4 v[176:179], v139, s[68:71], s100 offen offset:1024 sc1
  ds_read_b64_tr_b16 v[12:13], v133 offset:32768
  ds_read_b64_tr_b16 v[14:15], v133 offset:33280
  s_waitcnt vmcnt(15) lgkmcnt(8)
  v_mfma_f32_32x32x16_bf16 v[64:79], v[220:223], v[24:27], v[64:79]
  ds_read_b64_tr_b16 v[16:17], v129 offset:34816
  ds_read_b64_tr_b16 v[18:19], v129 offset:35328
  v_mfma_f32_32x32x16_bf16 v[80:95], v[220:223], v[28:31], v[80:95]
  buffer_load_dwordx4 v[180:183], v139, s[68:71], s55 offen offset:2048 sc1
  ds_read_b64_tr_b16 v[20:21], v133 offset:34816
  ds_read_b64_tr_b16 v[22:23], v133 offset:35328
  s_waitcnt vmcnt(15) lgkmcnt(8)
  v_mfma_f32_32x32x16_bf16 v[64:79], v[224:227], v[96:99], v[64:79]
  ds_read_b64_tr_b16 v[24:25], v129 offset:36864
  ds_read_b64_tr_b16 v[26:27], v129 offset:37376
  v_mfma_f32_32x32x16_bf16 v[80:95], v[224:227], v[100:103], v[80:95]
  buffer_load_dwordx4 v[184:187], v139, s[68:71], s55 offen offset:3072 sc1
  ds_read_b64_tr_b16 v[28:29], v133 offset:36864
  ds_read_b64_tr_b16 v[30:31], v133 offset:37376
  s_waitcnt vmcnt(15) lgkmcnt(8)
  v_mfma_f32_32x32x16_bf16 v[64:79], v[228:231], v[8:11], v[64:79]
  ds_read_b64_tr_b16 v[96:97], v129 offset:38912
  ds_read_b64_tr_b16 v[98:99], v129 offset:39424
  v_mfma_f32_32x32x16_bf16 v[80:95], v[228:231], v[12:15], v[80:95]
  s_add_u32 s100, s95, 2
  s_and_b32 s100, s100, 3
  s_bitcmp1_b32 s54, s100
  s_cselect_b32 s55, 0x40000000, 0
  s_lshl_b32 s100, s100, 13
  s_add_u32 s100, s100, s52
  s_add_u32 s55, s55, s100
  buffer_load_dwordx4 v[188:191], v139, s[68:71], s100 offen sc1
  ds_read_b64_tr_b16 v[100:101], v133 offset:38912
  ds_read_b64_tr_b16 v[102:103], v133 offset:39424
  s_waitcnt vmcnt(15) lgkmcnt(8)
  v_mfma_f32_32x32x16_bf16 v[64:79], v[232:235], v[16:19], v[64:79]
  s_barrier
  ds_read_b64_tr_b16 v[8:9], v129 offset:49152
  ds_read_b64_tr_b16 v[10:11], v129 offset:49664
  v_mfma_f32_32x32x16_bf16 v[80:95], v[232:235], v[20:23], v[80:95]
  buffer_load_dwordx4 v[192:195], v139, s[68:71], s100 offen offset:1024 sc1
  ds_read_b64_tr_b16 v[12:13], v133 offset:49152
  ds_read_b64_tr_b16 v[14:15], v133 offset:49664
  s_waitcnt vmcnt(15) lgkmcnt(8)
  v_mfma_f32_32x32x16_bf16 v[64:79], v[236:239], v[24:27], v[64:79]
  ds_read_b64_tr_b16 v[16:17], v129 offset:51200
  ds_read_b64_tr_b16 v[18:19], v129 offset:51712
  v_mfma_f32_32x32x16_bf16 v[80:95], v[236:239], v[28:31], v[80:95]
  buffer_load_dwordx4 v[196:199], v139, s[68:71], s55 offen offset:2048 sc1
  ds_read_b64_tr_b16 v[20:21], v133 offset:51200
  ds_read_b64_tr_b16 v[22:23], v133 offset:51712
  s_waitcnt vmcnt(15) lgkmcnt(8)
  v_mfma_f32_32x32x16_bf16 v[64:79], v[240:243], v[96:99], v[64:79]
  ds_read_b64_tr_b16 v[24:25], v129 offset:53248
  ds_read_b64_tr_b16 v[26:27], v129 offset:53760
  v_mfma_f32_32x32x16_bf16 v[80:95], v[240:243], v[100:103], v[80:95]
  buffer_load_dwordx4 v[200:203], v139, s[68:71], s55 offen offset:3072 sc1
  ds_read_b64_tr_b16 v[28:29], v133 offset:53248
  ds_read_b64_tr_b16 v[30:31], v133 offset:53760
  s_waitcnt vmcnt(15) lgkmcnt(8)
  v_mfma_f32_32x32x16_bf16 v[64:79], v[244:247], v[8:11], v[64:79]
  ds_read_b64_tr_b16 v[96:97], v129 offset:55296
  ds_read_b64_tr_b16 v[98:99], v129 offset:55808
  v_mfma_f32_32x32x16_bf16 v[80:95], v[244:247], v[12:15], v[80:95]
  s_add_u32 s100, s95, 3
  s_and_b32 s100, s100, 3
  s_bitcmp1_b32 s54, s100
  s_cselect_b32 s55, 0x40000000, 0
  s_lshl_b32 s100, s100, 13
  s_add_u32 s100, s100, s52
  s_add_u32 s55, s55, s100
  buffer_load_dwordx4 v[204:207], v139, s[68:71], s100 offen sc1
  ds_read_b64_tr_b16 v[100:101], v133 offset:55296
  ds_read_b64_tr_b16 v[102:103], v133 offset:55808
  s_waitcnt vmcnt(15) lgkmcnt(8)
  v_mfma_f32_32x32x16_bf16 v[64:79], v[248:251], v[16:19], v[64:79]
  v_add_u32 v129, 4294934528, v129
  v_add_u32 v133, 4294934528, v133
  ds_read_b64_tr_b16 v[8:9], v129 offset:0
  ds_read_b64_tr_b16 v[10:11], v129 offset:512
  v_mfma_f32_32x32x16_bf16 v[80:95], v[248:251], v[20:23], v[80:95]
  buffer_load_dwordx4 v[208:211], v139, s[68:71], s100 offen offset:1024 sc1
  ds_read_b64_tr_b16 v[12:13], v133 offset:0
  ds_read_b64_tr_b16 v[14:15], v133 offset:512
  s_waitcnt vmcnt(15) lgkmcnt(8)
  v_mfma_f32_32x32x16_bf16 v[64:79], v[252:255], v[24:27], v[64:79]
  ds_read_b64_tr_b16 v[16:17], v129 offset:2048
  ds_read_b64_tr_b16 v[18:19], v129 offset:2560
  v_mfma_f32_32x32x16_bf16 v[80:95], v[252:255], v[28:31], v[80:95]
  buffer_load_dwordx4 v[212:215], v139, s[68:71], s55 offen offset:2048 sc1
  ds_read_b64_tr_b16 v[20:21], v133 offset:2048
  ds_read_b64_tr_b16 v[22:23], v133 offset:2560
  s_waitcnt vmcnt(15) lgkmcnt(8)
  v_mfma_f32_32x32x16_bf16 v[64:79], v[108:111], v[96:99], v[64:79]
  ds_read_b64_tr_b16 v[24:25], v129 offset:4096
  ds_read_b64_tr_b16 v[26:27], v129 offset:4608
  v_mfma_f32_32x32x16_bf16 v[80:95], v[108:111], v[100:103], v[80:95]
  buffer_load_dwordx4 v[216:219], v139, s[68:71], s55 offen offset:3072 sc1
  ds_read_b64_tr_b16 v[28:29], v133 offset:4096
  ds_read_b64_tr_b16 v[30:31], v133 offset:4608
  s_waitcnt vmcnt(15) lgkmcnt(8)
  v_mfma_f32_32x32x16_bf16 v[64:79], v[112:115], v[8:11], v[64:79]
  ds_read_b64_tr_b16 v[96:97], v129 offset:6144
  ds_read_b64_tr_b16 v[98:99], v129 offset:6656
  v_mfma_f32_32x32x16_bf16 v[80:95], v[112:115], v[12:15], v[80:95]
  s_add_u32 s100, s95, 0
  s_and_b32 s100, s100, 3
  s_bitcmp1_b32 s54, s100
  s_cselect_b32 s55, 0x40000000, 0
  s_lshl_b32 s100, s100, 13
  s_add_u32 s100, s100, s52
  s_add_u32 s55, s55, s100
  buffer_load_dwordx4 v[220:223], v139, s[68:71], s100 offen sc1
  ds_read_b64_tr_b16 v[100:101], v133 offset:6144
  ds_read_b64_tr_b16 v[102:103], v133 offset:6656
  s_waitcnt vmcnt(15) lgkmcnt(8)
  v_mfma_f32_32x32x16_bf16 v[64:79], v[116:119], v[16:19], v[64:79]
  v_mfma_f32_32x32x16_bf16 v[80:95], v[116:119], v[20:23], v[80:95]
  buffer_load_dwordx4 v[224:227], v139, s[68:71], s100 offen offset:1024 sc1
  s_waitcnt vmcnt(15) lgkmcnt(4)
  v_mfma_f32_32x32x16_bf16 v[64:79], v[120:123], v[24:27], v[64:79]
  v_mfma_f32_32x32x16_bf16 v[80:95], v[120:123], v[28:31], v[80:95]
  buffer_load_dwordx4 v[228:231], v139, s[68:71], s55 offen offset:2048 sc1
  s_waitcnt vmcnt(15) lgkmcnt(0)
  v_mfma_f32_32x32x16_bf16 v[64:79], v[124:127], v[96:99], v[64:79]
  v_mfma_f32_32x32x16_bf16 v[80:95], v[124:127], v[100:103], v[80:95]
  buffer_load_dwordx4 v[232:235], v139, s[68:71], s55 offen offset:3072 sc1
  s_nop 10
  ds_write_b128 v128, v[80:83] offset:0
  ds_write_b128 v128, v[84:87] offset:1024
  ds_write_b128 v128, v[88:91] offset:2048
  ds_write_b128 v128, v[92:95] offset:3072
  v_xor_b32 v104, 4096, v128
  s_waitcnt lgkmcnt(0)
  s_barrier
  ds_read_b128 v[80:83], v104 offset:0
  ds_read_b128 v[84:87], v104 offset:1024
  ds_read_b128 v[88:91], v104 offset:2048
  ds_read_b128 v[92:95], v104 offset:3072
  v_mov_b32 v163, s90
  v_mov_b32 v167, s90
  v_mov_b32 v171, s90
  v_mov_b32 v170, 0
  s_waitcnt lgkmcnt(3)
  v_add_f32 v64, v64, v80
  v_add_f32 v65, v65, v81
  v_cvt_pk_bf16_f32 v160, v64, v65
  v_add_f32 v66, v66, v82
  v_add_f32 v67, v67, v83
  v_cvt_pk_bf16_f32 v161, v66, v67
  s_waitcnt lgkmcnt(2)
  v_add_f32 v68, v68, v84
  v_add_f32 v69, v69, v85
  v_cvt_pk_bf16_f32 v162, v68, v69
  buffer_store_dwordx4 v[160:163], v0, s[68:71], s21 offen offset:0 sc1
  v_add_f32 v70, v70, v86
  v_add_f32 v71, v71, v87
  v_cvt_pk_bf16_f32 v164, v70, v71
  s_waitcnt lgkmcnt(1)
  v_add_f32 v72, v72, v88
  v_add_f32 v73, v73, v89
  v_cvt_pk_bf16_f32 v165, v72, v73
  v_add_f32 v74, v74, v90
  v_add_f32 v75, v75, v91
  v_cvt_pk_bf16_f32 v166, v74, v75
  buffer_store_dwordx4 v[164:167], v0, s[68:71], s21 offen offset:1024 sc1
  s_waitcnt lgkmcnt(0)
  v_add_f32 v76, v76, v92
  v_add_f32 v77, v77, v93
  v_cvt_pk_bf16_f32 v168, v76, v77
  v_add_f32 v78, v78, v94
  v_add_f32 v79, v79, v95
  v_cvt_pk_bf16_f32 v169, v78, v79
  buffer_store_dwordx4 v[168:171], v0, s[68:71], s21 offen offset:2048 sc1
  v_add_u32 v129, 4294918144, v129
  v_add_u32 v133, 4294918144, v133
  ds_read_b64_tr_b16 v[8:9], v129 offset:0
  ds_read_b64_tr_b16 v[10:11], v129 offset:512
  ds_read_b64_tr_b16 v[12:13], v133 offset:0
  ds_read_b64_tr_b16 v[14:15], v133 offset:512
  ds_read_b64_tr_b16 v[16:17], v129 offset:2048
  ds_read_b64_tr_b16 v[18:19], v129 offset:2560
  ds_read_b64_tr_b16 v[20:21], v133 offset:2048
  ds_read_b64_tr_b16 v[22:23], v133 offset:2560
  ds_read_b64_tr_b16 v[24:25], v129 offset:4096
  ds_read_b64_tr_b16 v[26:27], v129 offset:4608
  ds_read_b64_tr_b16 v[28:29], v133 offset:4096
  ds_read_b64_tr_b16 v[30:31], v133 offset:4608
  s_waitcnt vmcnt(18) lgkmcnt(8)
  v_mfma_f32_32x32x16_bf16 v[32:47], v[172:175], v[8:11], v[32:47]
  ds_read_b64_tr_b16 v[96:97], v129 offset:6144
  ds_read_b64_tr_b16 v[98:99], v129 offset:6656
  v_mfma_f32_32x32x16_bf16 v[48:63], v[172:175], v[12:15], v[48:63]
  s_add_u32 s100, s95, 4
  s_and_b32 s100, s100, 1
  s_add_u32 s100, s100, 4
  s_bitcmp1_b32 s54, s100
  s_cselect_b32 s55, 0x40000000, 0
  s_lshl_b32 s100, s100, 13
  s_add_u32 s100, s100, s52
  s_add_u32 s55, s55, s100
  buffer_load_dwordx4 v[236:239], v139, s[68:71], s100 offen sc1
  ds_read_b64_tr_b16 v[100:101], v133 offset:6144
  ds_read_b64_tr_b16 v[102:103], v133 offset:6656
  s_waitcnt vmcnt(18) lgkmcnt(8)
  v_mfma_f32_32x32x16_bf16 v[32:47], v[176:179], v[16:19], v[32:47]
  ds_read_b64_tr_b16 v[8:9], v129 offset:16384
  ds_read_b64_tr_b16 v[10:11], v129 offset:16896
  v_mfma_f32_32x32x16_bf16 v[48:63], v[176:179], v[20:23], v[48:63]
  buffer_load_dwordx4 v[240:243], v139, s[68:71], s100 offen offset:1024 sc1
  ds_read_b64_tr_b16 v[12:13], v133 offset:16384
  ds_read_b64_tr_b16 v[14:15], v133 offset:16896
  s_waitcnt vmcnt(18) lgkmcnt(8)
  v_mfma_f32_32x32x16_bf16 v[32:47], v[180:183], v[24:27], v[32:47]
  ds_read_b64_tr_b16 v[16:17], v129 offset:18432
  ds_read_b64_tr_b16 v[18:19], v129 offset:18944
  v_mfma_f32_32x32x16_bf16 v[48:63], v[180:183], v[28:31], v[48:63]
  buffer_load_dwordx4 v[244:247], v139, s[68:71], s55 offen offset:2048 sc1
  ds_read_b64_tr_b16 v[20:21], v133 offset:18432
  ds_read_b64_tr_b16 v[22:23], v133 offset:18944
  s_waitcnt vmcnt(18) lgkmcnt(8)
  v_mfma_f32_32x32x16_bf16 v[32:47], v[184:187], v[96:99], v[32:47]
  ds_read_b64_tr_b16 v[24:25], v129 offset:20480
  ds_read_b64_tr_b16 v[26:27], v129 offset:20992
  v_mfma_f32_32x32x16_bf16 v[48:63], v[184:187], v[100:103], v[48:63]
  buffer_load_dwordx4 v[248:251], v139, s[68:71], s55 offen offset:3072 sc1
  ds_read_b64_tr_b16 v[28:29], v133 offset:20480
  ds_read_b64_tr_b16 v[30:31], v133 offset:20992
  s_waitcnt vmcnt(18) lgkmcnt(8)
  v_mfma_f32_32x32x16_bf16 v[32:47], v[188:191], v[8:11], v[32:47]
  ds_read_b64_tr_b16 v[96:97], v129 offset:22528
  ds_read_b64_tr_b16 v[98:99], v129 offset:23040
  v_mfma_f32_32x32x16_bf16 v[48:63], v[188:191], v[12:15], v[48:63]
  s_add_u32 s100, s95, 5
  s_and_b32 s100, s100, 1
  s_add_u32 s100, s100, 4
  s_bitcmp1_b32 s54, s100
  s_cselect_b32 s55, 0x40000000, 0
  s_lshl_b32 s100, s100, 13
  s_add_u32 s100, s100, s52
  s_add_u32 s55, s55, s100
  buffer_load_dwordx4 v[252:255], v139, s[68:71], s100 offen sc1
  ds_read_b64_tr_b16 v[100:101], v133 offset:22528
  ds_read_b64_tr_b16 v[102:103], v133 offset:23040
  s_waitcnt vmcnt(18) lgkmcnt(8)
  v_mfma_f32_32x32x16_bf16 v[32:47], v[192:195], v[16:19], v[32:47]
  s_barrier
  ds_read_b64_tr_b16 v[8:9], v129 offset:32768
  ds_read_b64_tr_b16 v[10:11], v129 offset:33280
  v_mfma_f32_32x32x16_bf16 v[48:63], v[192:195], v[20:23], v[48:63]
  buffer_load_dwordx4 v[108:111], v139, s[68:71], s100 offen offset:1024 sc1
  ds_read_b64_tr_b16 v[12:13], v133 offset:32768
  ds_read_b64_tr_b16 v[14:15], v133 offset:33280
  s_waitcnt vmcnt(18) lgkmcnt(8)
  v_mfma_f32_32x32x16_bf16 v[32:47], v[196:199], v[24:27], v[32:47]
  ds_read_b64_tr_b16 v[16:17], v129 offset:34816
  ds_read_b64_tr_b16 v[18:19], v129 offset:35328
  v_mfma_f32_32x32x16_bf16 v[48:63], v[196:199], v[28:31], v[48:63]
  buffer_load_dwordx4 v[112:115], v139, s[68:71], s55 offen offset:2048 sc1
  ds_read_b64_tr_b16 v[20:21], v133 offset:34816
  ds_read_b64_tr_b16 v[22:23], v133 offset:35328
  s_waitcnt vmcnt(18) lgkmcnt(8)
  v_mfma_f32_32x32x16_bf16 v[32:47], v[200:203], v[96:99], v[32:47]
  ds_read_b64_tr_b16 v[24:25], v129 offset:36864
  ds_read_b64_tr_b16 v[26:27], v129 offset:37376
  v_mfma_f32_32x32x16_bf16 v[48:63], v[200:203], v[100:103], v[48:63]
  buffer_load_dwordx4 v[116:119], v139, s[68:71], s55 offen offset:3072 sc1
  ds_read_b64_tr_b16 v[28:29], v133 offset:36864
  ds_read_b64_tr_b16 v[30:31], v133 offset:37376
  s_waitcnt vmcnt(18) lgkmcnt(8)
  v_mfma_f32_32x32x16_bf16 v[32:47], v[204:207], v[8:11], v[32:47]
  ds_read_b64_tr_b16 v[96:97], v129 offset:38912
  ds_read_b64_tr_b16 v[98:99], v129 offset:39424
  v_mfma_f32_32x32x16_bf16 v[48:63], v[204:207], v[12:15], v[48:63]
  s_add_u32 s100, s95, 0
  s_and_b32 s100, s100, 3
  s_lshl2_add_u32 s100, s7, s100
  s_lshl_b32 s100, s100, 13
  buffer_load_dwordx4 v[120:123], v139, s[68:71], s100 offen sc1
  ds_read_b64_tr_b16 v[100:101], v133 offset:38912
  ds_read_b64_tr_b16 v[102:103], v133 offset:39424
  s_waitcnt vmcnt(18) lgkmcnt(8)
  v_mfma_f32_32x32x16_bf16 v[32:47], v[208:211], v[16:19], v[32:47]
  v_add_u32 v129, 81920, v129
  v_add_u32 v133, 81920, v133
  ds_read_b64_tr_b16 v[8:9], v129 offset:32768
  ds_read_b64_tr_b16 v[10:11], v129 offset:33280
  v_mfma_f32_32x32x16_bf16 v[48:63], v[208:211], v[20:23], v[48:63]
  buffer_load_dwordx4 v[124:127], v139, s[68:71], s100 offen offset:1024 sc1
  ds_read_b64_tr_b16 v[12:13], v133 offset:32768
  ds_read_b64_tr_b16 v[14:15], v133 offset:33280
  s_waitcnt vmcnt(18) lgkmcnt(8)
  v_mfma_f32_32x32x16_bf16 v[32:47], v[212:215], v[24:27], v[32:47]
  ds_read_b64_tr_b16 v[16:17], v129 offset:34816
  ds_read_b64_tr_b16 v[18:19], v129 offset:35328
  v_mfma_f32_32x32x16_bf16 v[48:63], v[212:215], v[28:31], v[48:63]
  buffer_load_dwordx4 v[172:175], v139, s[68:71], s100 offen offset:2048 sc1
  ds_read_b64_tr_b16 v[20:21], v133 offset:34816
  ds_read_b64_tr_b16 v[22:23], v133 offset:35328
  s_waitcnt vmcnt(18) lgkmcnt(8)
  v_mfma_f32_32x32x16_bf16 v[32:47], v[216:219], v[96:99], v[32:47]
  ds_read_b64_tr_b16 v[24:25], v129 offset:36864
  ds_read_b64_tr_b16 v[26:27], v129 offset:37376
  v_mfma_f32_32x32x16_bf16 v[48:63], v[216:219], v[100:103], v[48:63]
  buffer_load_dwordx4 v[176:179], v139, s[68:71], s100 offen offset:3072 sc1
  ds_read_b64_tr_b16 v[28:29], v133 offset:36864
  ds_read_b64_tr_b16 v[30:31], v133 offset:37376
  s_waitcnt vmcnt(18) lgkmcnt(8)
  v_mfma_f32_32x32x16_bf16 v[32:47], v[220:223], v[8:11], v[32:47]
  ds_read_b64_tr_b16 v[96:97], v129 offset:38912
  ds_read_b64_tr_b16 v[98:99], v129 offset:39424
  v_mfma_f32_32x32x16_bf16 v[48:63], v[220:223], v[12:15], v[48:63]
  ds_read_b64_tr_b16 v[100:101], v133 offset:38912
  ds_read_b64_tr_b16 v[102:103], v133 offset:39424
  s_waitcnt vmcnt(17) lgkmcnt(8)
  v_mfma_f32_32x32x16_bf16 v[32:47], v[224:227], v[16:19], v[32:47]
  ds_read_b64_tr_b16 v[8:9], v129 offset:49152
  ds_read_b64_tr_b16 v[10:11], v129 offset:49664
  v_mfma_f32_32x32x16_bf16 v[48:63], v[224:227], v[20:23], v[48:63]
  ds_read_b64_tr_b16 v[12:13], v133 offset:49152
  ds_read_b64_tr_b16 v[14:15], v133 offset:49664
  s_waitcnt vmcnt(16) lgkmcnt(8)
  v_mfma_f32_32x32x16_bf16 v[32:47], v[228:231], v[24:27], v[32:47]
  ds_read_b64_tr_b16 v[16:17], v129 offset:51200
  ds_read_b64_tr_b16 v[18:19], v129 offset:51712
  v_mfma_f32_32x32x16_bf16 v[48:63], v[228:231], v[28:31], v[48:63]
  ds_read_b64_tr_b16 v[20:21], v133 offset:51200
  ds_read_b64_tr_b16 v[22:23], v133 offset:51712
  s_waitcnt vmcnt(15) lgkmcnt(8)
  v_mfma_f32_32x32x16_bf16 v[32:47], v[232:235], v[96:99], v[32:47]
  ds_read_b64_tr_b16 v[24:25], v129 offset:53248
  ds_read_b64_tr_b16 v[26:27], v129 offset:53760
  v_mfma_f32_32x32x16_bf16 v[48:63], v[232:235], v[100:103], v[48:63]
  ds_read_b64_tr_b16 v[28:29], v133 offset:53248
  ds_read_b64_tr_b16 v[30:31], v133 offset:53760
  s_waitcnt vmcnt(11) lgkmcnt(8)
  v_mfma_f32_32x32x16_bf16 v[32:47], v[236:239], v[8:11], v[32:47]
  ds_read_b64_tr_b16 v[96:97], v129 offset:55296
  ds_read_b64_tr_b16 v[98:99], v129 offset:55808
  v_mfma_f32_32x32x16_bf16 v[48:63], v[236:239], v[12:15], v[48:63]
  ds_read_b64_tr_b16 v[100:101], v133 offset:55296
  ds_read_b64_tr_b16 v[102:103], v133 offset:55808
  s_waitcnt vmcnt(10) lgkmcnt(8)
  v_mfma_f32_32x32x16_bf16 v[32:47], v[240:243], v[16:19], v[32:47]
  v_add_u32 v129, 4294934528, v129
  v_add_u32 v133, 4294934528, v133
  ds_read_b64_tr_b16 v[8:9], v129 offset:0
  ds_read_b64_tr_b16 v[10:11], v129 offset:512
  v_mfma_f32_32x32x16_bf16 v[48:63], v[240:243], v[20:23], v[48:63]
  ds_read_b64_tr_b16 v[12:13], v133 offset:0
  ds_read_b64_tr_b16 v[14:15], v133 offset:512
  s_waitcnt vmcnt(9) lgkmcnt(8)
  v_mfma_f32_32x32x16_bf16 v[32:47], v[244:247], v[24:27], v[32:47]
  ds_read_b64_tr_b16 v[16:17], v129 offset:2048
  ds_read_b64_tr_b16 v[18:19], v129 offset:2560
  v_mfma_f32_32x32x16_bf16 v[48:63], v[244:247], v[28:31], v[48:63]
  ds_read_b64_tr_b16 v[20:21], v133 offset:2048
  ds_read_b64_tr_b16 v[22:23], v133 offset:2560
  s_waitcnt vmcnt(8) lgkmcnt(8)
  v_mfma_f32_32x32x16_bf16 v[32:47], v[248:251], v[96:99], v[32:47]
  ds_read_b64_tr_b16 v[24:25], v129 offset:4096
  ds_read_b64_tr_b16 v[26:27], v129 offset:4608
  v_mfma_f32_32x32x16_bf16 v[48:63], v[248:251], v[100:103], v[48:63]
  ds_read_b64_tr_b16 v[28:29], v133 offset:4096
  ds_read_b64_tr_b16 v[30:31], v133 offset:4608
  s_waitcnt vmcnt(7) lgkmcnt(8)
  v_mfma_f32_32x32x16_bf16 v[32:47], v[252:255], v[8:11], v[32:47]
  ds_read_b64_tr_b16 v[96:97], v129 offset:6144
  ds_read_b64_tr_b16 v[98:99], v129 offset:6656
  v_mfma_f32_32x32x16_bf16 v[48:63], v[252:255], v[12:15], v[48:63]
  buffer_load_dwordx4 v[80:83], v0, s[68:71], s20 offen offset:0 sc1
  buffer_load_dwordx4 v[84:87], v0, s[68:71], s20 offen offset:1024 sc1
  buffer_load_dwordx4 v[88:91], v0, s[68:71], s20 offen offset:2048 sc1
  ds_read_b64_tr_b16 v[100:101], v133 offset:6144
  ds_read_b64_tr_b16 v[102:103], v133 offset:6656
  s_waitcnt vmcnt(9) lgkmcnt(8)
  v_mfma_f32_32x32x16_bf16 v[32:47], v[108:111], v[16:19], v[32:47]
  ds_read_b128 v[8:11], v134 offset:49152
  v_mfma_f32_32x32x16_bf16 v[48:63], v[108:111], v[20:23], v[48:63]
  ds_read_b128 v[12:15], v2 offset:49152
  s_waitcnt vmcnt(8) lgkmcnt(6)
  v_mfma_f32_32x32x16_bf16 v[32:47], v[112:115], v[24:27], v[32:47]
  ds_read_b128 v[16:19], v135 offset:49152
  v_mfma_f32_32x32x16_bf16 v[48:63], v[112:115], v[28:31], v[48:63]
  ds_read_b128 v[20:23], v3 offset:49152
  s_waitcnt vmcnt(7) lgkmcnt(4)
  v_mfma_f32_32x32x16_bf16 v[32:47], v[116:119], v[96:99], v[32:47]
  ds_read_b128 v[24:27], v136 offset:49152
  v_mfma_f32_32x32x16_bf16 v[48:63], v[116:119], v[100:103], v[48:63]
  ds_read_b128 v[28:31], v4 offset:49152
  s_waitcnt vmcnt(6) lgkmcnt(4)
  v_mfma_f32_32x32x16_bf16 v[32:47], v[120:123], v[8:11], v[32:47]
  ds_read_b128 v[96:99], v137 offset:49152
  v_mfma_f32_32x32x16_bf16 v[48:63], v[120:123], v[12:15], v[48:63]
  ds_read_b128 v[100:103], v5 offset:49152
  s_waitcnt vmcnt(5) lgkmcnt(4)
  v_mfma_f32_32x32x16_bf16 v[32:47], v[124:127], v[16:19], v[32:47]
  v_mfma_f32_32x32x16_bf16 v[48:63], v[124:127], v[20:23], v[48:63]
  s_waitcnt vmcnt(4) lgkmcnt(2)
  v_mfma_f32_32x32x16_bf16 v[32:47], v[172:175], v[24:27], v[32:47]
  v_mfma_f32_32x32x16_bf16 v[48:63], v[172:175], v[28:31], v[48:63]
  s_waitcnt vmcnt(3) lgkmcnt(0)
  v_mfma_f32_32x32x16_bf16 v[32:47], v[176:179], v[96:99], v[32:47]
  v_mfma_f32_32x32x16_bf16 v[48:63], v[176:179], v[100:103], v[48:63]
  v_add_u32 v128, 4294901760, v128
  s_nop 10
  ds_write_b128 v128, v[48:51] offset:0
  ds_write_b128 v128, v[52:55] offset:1024
  ds_write_b128 v128, v[56:59] offset:2048
  ds_write_b128 v128, v[60:63] offset:3072
  v_xor_b32 v104, 4096, v128
  s_waitcnt lgkmcnt(0)
  s_barrier
  ds_read_b128 v[48:51], v104 offset:0
  ds_read_b128 v[52:55], v104 offset:1024
  ds_read_b128 v[56:59], v104 offset:2048
  ds_read_b128 v[60:63], v104 offset:3072
  v_add_f32 v32, v32, v144
  v_add_f32 v33, v33, v145
  v_add_f32 v34, v34, v146
  v_add_f32 v35, v35, v147
  v_add_f32 v36, v36, v148
  v_add_f32 v37, v37, v149
  v_add_f32 v38, v38, v150
  v_add_f32 v39, v39, v151
  v_add_f32 v40, v40, v152
  v_add_f32 v41, v41, v153
  v_add_f32 v42, v42, v154
  v_add_f32 v43, v43, v155
  v_add_f32 v44, v44, v156
  v_add_f32 v45, v45, v157
  v_add_f32 v46, v46, v158
  v_add_f32 v47, v47, v159
  s_waitcnt vmcnt(0)
  v_xor_b32 v64, v171, v83
  v_xor_b32 v65, v171, v87
  v_xor_b32 v66, v171, v91
  v_or3_b32 v64, v64, v65, v66
  v_cmp_ne_u32 vcc, 0, v64
  s_cbranch_vccnz L_slow_p
L_back_p:
  s_mov_b32 s16, 0xffff0000
  v_lshlrev_b32 v64, 16, v80
  v_and_b32 v65, s16, v80
  v_add_f32 v32, v32, v64
  v_add_f32 v33, v33, v65
  v_lshlrev_b32 v64, 16, v81
  v_and_b32 v65, s16, v81
  v_add_f32 v34, v34, v64
  v_add_f32 v35, v35, v65
  v_lshlrev_b32 v64, 16, v82
  v_and_b32 v65, s16, v82
  v_add_f32 v36, v36, v64
  v_add_f32 v37, v37, v65
  v_lshlrev_b32 v64, 16, v84
  v_and_b32 v65, s16, v84
  v_add_f32 v38, v38, v64
  v_add_f32 v39, v39, v65
  v_lshlrev_b32 v64, 16, v85
  v_and_b32 v65, s16, v85
  v_add_f32 v40, v40, v64
  v_add_f32 v41, v41, v65
  v_lshlrev_b32 v64, 16, v86
  v_and_b32 v65, s16, v86
  v_add_f32 v42, v42, v64
  v_add_f32 v43, v43, v65
  v_lshlrev_b32 v64, 16, v88
  v_and_b32 v65, s16, v88
  v_add_f32 v44, v44, v64
  v_add_f32 v45, v45, v65
  v_lshlrev_b32 v64, 16, v89
  v_and_b32 v65, s16, v89
  v_add_f32 v46, v46, v64
  v_add_f32 v47, v47, v65
  s_waitcnt lgkmcnt(3)
  v_add_f32 v32, v32, v48
  s_mov_b32 s9, 0
  buffer_store_dword v32, v132, s[72:75], s9 offen offset:0 sc1
  v_add_f32 v33, v33, v49
  buffer_store_dword v33, v132, s[72:75], s9 offen offset:2048 sc1
  v_add_f32 v34, v34, v50
  s_mov_b32 s9, 4096
  buffer_store_dword v34, v132, s[72:75], s9 offen offset:0 sc1
  v_add_f32 v35, v35, v51
  buffer_store_dword v35, v132, s[72:75], s9 offen offset:2048 sc1
  s_waitcnt lgkmcnt(2)
  v_add_f32 v36, v36, v52
  s_mov_b32 s9, 8192
  buffer_store_dword v36, v132, s[72:75], s9 offen offset:0 sc1
  v_add_f32 v37, v37, v53
  buffer_store_dword v37, v132, s[72:75], s9 offen offset:2048 sc1
  v_add_f32 v38, v38, v54
  s_mov_b32 s9, 12288
  buffer_store_dword v38, v132, s[72:75], s9 offen offset:0 sc1
  v_add_f32 v39, v39, v55
  buffer_store_dword v39, v132, s[72:75], s9 offen offset:2048 sc1
  s_waitcnt lgkmcnt(1)
  v_add_f32 v40, v40, v56
  s_mov_b32 s9, 16384
  buffer_store_dword v40, v132, s[72:75], s9 offen offset:0 sc1
  v_add_f32 v41, v41, v57
  buffer_store_dword v41, v132, s[72:75], s9 offen offset:2048 sc1
  v_add_f32 v42, v42, v58
  s_mov_b32 s9, 20480
  buffer_store_dword v42, v132, s[72:75], s9 offen offset:0 sc1
  v_add_f32 v43, v43, v59
  buffer_store_dword v43, v132, s[72:75], s9 offen offset:2048 sc1
  s_waitcnt lgkmcnt(0)
  v_add_f32 v44, v44, v60
  s_mov_b32 s9, 24576
  buffer_store_dword v44, v132, s[72:75], s9 offen offset:0 sc1
  v_add_f32 v45, v45, v61
  buffer_store_dword v45, v132, s[72:75], s9 offen offset:2048 sc1
  v_add_f32 v46, v46, v62
  s_mov_b32 s9, 28672
  buffer_store_dword v46, v132, s[72:75], s9 offen offset:0 sc1
  v_add_f32 v47, v47, v63
  buffer_store_dword v47, v132, s[72:75], s9 offen offset:2048 sc1
  s_endpgm
L_slow_chk1:
  ds_read_b32 v73, v72 offset:16
  s_waitcnt lgkmcnt(0)
  v_cmp_gt_u32 vcc, 2, v73
  s_add_u32 s97, s97, 1
  s_cmp_gt_u32 s97, 0x200000
  s_cbranch_scc1 L_back_chk1
  s_cbranch_vccnz L_slow_chk1
  s_branch L_back_chk1
L_slow_chk2:
  ds_read_b32 v73, v72 offset:16
  s_waitcnt lgkmcnt(0)
  v_cmp_gt_u32 vcc, 4, v73
  s_add_u32 s97, s97, 1
  s_cmp_gt_u32 s97, 0x200000
  s_cbranch_scc1 L_back_chk2
  s_cbranch_vccnz L_slow_chk2
  s_branch L_back_chk2
L_slow_chk3:
  ds_read_b32 v73, v72 offset:16
  s_waitcnt lgkmcnt(0)
  v_cmp_gt_u32 vcc, 5, v73
  s_add_u32 s97, s97, 1
  s_cmp_gt_u32 s97, 0x200000
  s_cbranch_scc1 L_back_chk3
  s_cbranch_vccnz L_slow_chk3
  s_branch L_back_chk3
L_slow_chk4:
  ds_read_b32 v3, v2 offset:0
  s_waitcnt lgkmcnt(0)
  v_cmp_gt_u32 vcc, 4, v3
  s_add_u32 s97, s97, 1
  s_cmp_gt_u32 s97, 0x200000
  s_cbranch_scc1 L_back_chk4
  s_cbranch_vccnz L_slow_chk4
  s_branch L_back_chk4
L_slow_chk5:
  ds_read_b32 v3, v2 offset:16
  s_waitcnt lgkmcnt(0)
  v_cmp_gt_u32 vcc, 6, v3
  s_add_u32 s97, s97, 1
  s_cmp_gt_u32 s97, 0x200000
  s_cbranch_scc1 L_back_chk5
  s_cbranch_vccnz L_slow_chk5
  s_branch L_back_chk5
L_slow_chk6:
  ds_read_b32 v137, v2 offset:0
  s_waitcnt lgkmcnt(0)
  v_cmp_gt_u32 vcc, 6, v137
  s_add_u32 s97, s97, 1
  s_cmp_gt_u32 s97, 0x200000
  s_cbranch_scc1 L_back_chk6
  s_cbranch_vccnz L_slow_chk6
  s_branch L_back_chk6
L_slow_chk7:
  ds_read_b32 v3, v2 offset:16
  s_waitcnt lgkmcnt(0)
  v_cmp_gt_u32 vcc, 7, v3
  s_add_u32 s97, s97, 1
  s_cmp_gt_u32 s97, 0x200000
  s_cbranch_scc1 L_back_chk7
  s_cbranch_vccnz L_slow_chk7
  s_branch L_back_chk7
L_slow_chk8:
  ds_read_b32 v137, v2 offset:0
  s_waitcnt lgkmcnt(0)
  v_cmp_gt_u32 vcc, 7, v137
  s_add_u32 s97, s97, 1
  s_cmp_gt_u32 s97, 0x200000
  s_cbranch_scc1 L_back_chk8
  s_cbranch_vccnz L_slow_chk8
  s_branch L_back_chk8
L_slow_chk9:
  ds_read_b32 v3, v2 offset:16
  s_waitcnt lgkmcnt(0)
  v_cmp_gt_u32 vcc, 8, v3
  s_add_u32 s97, s97, 1
  s_cmp_gt_u32 s97, 0x200000
  s_cbranch_scc1 L_back_chk9
  s_cbranch_vccnz L_slow_chk9
  s_branch L_back_chk9
L_slow_chk10:
  ds_read_b32 v3, v2 offset:0
  s_waitcnt lgkmcnt(0)
  v_cmp_gt_u32 vcc, 8, v3
  s_add_u32 s97, s97, 1
  s_cmp_gt_u32 s97, 0x200000
  s_cbranch_scc1 L_back_chk10
  s_cbranch_vccnz L_slow_chk10
  s_branch L_back_chk10
L_slow_chk11:
  ds_read_b32 v3, v2 offset:0
  s_waitcnt lgkmcnt(0)
  v_cmp_gt_u32 vcc, 9, v3
  s_add_u32 s97, s97, 1
  s_cmp_gt_u32 s97, 0x200000
  s_cbranch_scc1 L_back_chk11
  s_cbranch_vccnz L_slow_chk11
  s_branch L_back_chk11
L_slow_chk12:
  ds_read_b32 v3, v2 offset:0
  s_waitcnt lgkmcnt(0)
  v_cmp_gt_u32 vcc, 10, v3
  s_add_u32 s97, s97, 1
  s_cmp_gt_u32 s97, 0x200000
  s_cbranch_scc1 L_back_chk12
  s_cbranch_vccnz L_slow_chk12
  s_branch L_back_chk12
L_slow_chk14:
  ds_read_b32 v104, v106 offset:16
  s_waitcnt lgkmcnt(0)
  v_cmp_gt_u32 vcc, 11, v104
  s_add_u32 s97, s97, 1
  s_cmp_gt_u32 s97, 0x200000
  s_cbranch_scc1 L_back_chk14
  s_cbranch_vccnz L_slow_chk14
  s_branch L_back_chk14
L_slow_chk15:
  ds_read_b32 v104, v106 offset:16
  s_waitcnt lgkmcnt(0)
  v_cmp_gt_u32 vcc, 12, v104
  s_add_u32 s97, s97, 1
  s_cmp_gt_u32 s97, 0x200000
  s_cbranch_scc1 L_back_chk15
  s_cbranch_vccnz L_slow_chk15
  s_branch L_back_chk15
L_slow_p:
  buffer_load_dwordx4 v[80:83], v0, s[68:71], s20 offen offset:0 sc1
  buffer_load_dwordx4 v[84:87], v0, s[68:71], s20 offen offset:1024 sc1
  buffer_load_dwordx4 v[88:91], v0, s[68:71], s20 offen offset:2048 sc1
  s_waitcnt vmcnt(0)
  v_xor_b32 v64, v171, v83
  v_xor_b32 v65, v171, v87
  v_xor_b32 v66, v171, v91
  v_or3_b32 v64, v64, v65, v66
  v_cmp_ne_u32 vcc, 0, v64
  s_add_u32 s97, s97, 1
  s_cmp_gt_u32 s97, 0x200000
  s_cbranch_scc1 L_back_p
  s_cbranch_vccnz L_slow_p
  s_branch L_back_p
L_slow_tagH:
  s_sleep 1
  v_mov_b32 v88, 0
  buffer_load_dword v21, v88, s[76:79], 0 offen sc1
  s_waitcnt vmcnt(0)
  v_readfirstlane_b32 s90, v21
  s_add_u32 s97, s97, 1
  s_cmp_gt_u32 s97, 0x200000
  s_cbranch_scc1 L_back_tagH
  s_cmp_eq_u32 s90, 0
  s_cbranch_scc1 L_slow_tagH
  s_branch L_back_tagH
L_slow_e:
  buffer_load_dwordx4 v[64:67], v42, s[68:71], 0 offen sc1
  buffer_load_dwordx4 v[68:71], v43, s[68:71], 0 offen sc1
  s_waitcnt vmcnt(0)
  v_xor_b32 v72, v65, v44
  v_xor_b32 v73, v67, v44
  v_xor_b32 v74, v69, v45
  v_or3_b32 v72, v72, v73, v74
  v_xor_b32 v73, v71, v45
  v_or_b32 v72, v72, v73
  v_cmp_ne_u32 vcc, 0, v72
  s_add_u32 s97, s97, 1
  s_cmp_gt_u32 s97, 0x200000
  s_cbranch_scc1 L_back_e
  s_cbranch_vccnz L_slow_e
  s_branch L_back_e
L_pad:
.fill (37120 - (L_pad - parallel_sum__ssm_conv_s5__glu_gated_bilinear__prompt_kernel)) / 4, 4, 0xbf810000
.section .rodata,"a"
.p2align 6
.amdhsa_kernel parallel_sum__ssm_conv_s5__glu_gated_bilinear__prompt_kernel
  .amdhsa_next_free_vgpr 256
  .amdhsa_next_free_sgpr 102
  .amdhsa_accum_offset 256
  .amdhsa_group_segment_fixed_size 0
  .amdhsa_kernarg_size 128
  .amdhsa_user_sgpr_count 2
  .amdhsa_user_sgpr_kernarg_segment_ptr 1
  .amdhsa_system_sgpr_workgroup_id_x 1
.end_amdhsa_kernel
```
